```python
import torch

def _softmax(x, axis=-1):
    return torch.softmax(x, dim=axis)
def _gelu(x):
    return torch.nn.functional.gelu(x, approximate="tanh")
def _silu(x):
    return torch.nn.functional.silu(x)
def _sigmoid(x):
    return torch.sigmoid(x)
def _layernorm(x, axis=-1, eps=1e-5):
    m = x.mean(dim=axis, keepdim=True)
    v = x.var(dim=axis, keepdim=True, unbiased=False)
    return (x - m) / torch.sqrt(v + eps)
def _scatter_add(tgt, idx, src, axis=0):
    return tgt.clone().index_add_(axis, idx, src)
def _segment_sum(src, seg, n):
    out = torch.zeros((n,) + src.shape[1:], dtype=src.dtype)
    return out.index_add_(0, seg, src)
def _pad(x, pw):
    flat = tuple(v for pair in reversed(pw) for v in pair)
    return torch.nn.functional.pad(x, flat)

kernel_name = 'parallel_sum__linear_kernel_hedgehog__moe_arch_mod__prompt'

def setup_inputs():

    _w = (lambda a: (lambda t: t.to(torch.bfloat16) if t.is_floating_point() else t)(torch.as_tensor(a)))
    def _A_setup():
        B, S, D, H = 1, 2048, 640, 32
        Dh = D // H
        return {
            "x": _w((lambda *s: torch.randn(*s, dtype=torch.bfloat16) * 0.05)(B, S, D)),
            "wqkv": _w((lambda *s: torch.randn(*s, dtype=torch.bfloat16) * 0.4)(D, 3 * D)),
            "w_phi": _w((lambda *s: torch.randn(*s, dtype=torch.bfloat16) * 0.4)(H, Dh, Dh) * (Dh ** -0.5)),
            "wo": _w((lambda *s: torch.randn(*s, dtype=torch.bfloat16) * 0.1)(D, D)),
        }
    _A_in = _A_setup()

    def _B_setup():
        B, S, D, F, C = 1, 2048, 640, 1536, 1
        return {
            "x": _w((lambda *s: torch.randn(*s, dtype=torch.bfloat16) * 0.05)(B, S, D)),
            "w_r": _w((lambda *s: torch.randn(*s, dtype=torch.bfloat16) * 0.05)(D)),
            "w_gate": _w((lambda *s: torch.randn(*s, dtype=torch.bfloat16) * 0.05)(D, F)),
            "w_up": _w((lambda *s: torch.randn(*s, dtype=torch.bfloat16) * 0.05)(D, F)),
            "w_down": _w((lambda *s: torch.randn(*s, dtype=torch.bfloat16) * 0.05)(F, D)),
        }
    _B_in = _B_setup()

    return {
        "A_x": _A_in["x"],
        "A_wqkv": _A_in["wqkv"],
        "A_w_phi": _A_in["w_phi"],
        "A_wo": _A_in["wo"],
        "B_x": _B_in["x"],
        "B_w_r": _B_in["w_r"],
        "B_w_gate": _B_in["w_gate"],
        "B_w_up": _B_in["w_up"],
        "B_w_down": _B_in["w_down"],
    }

def reference(A_x, A_wqkv, A_w_phi, A_wo, B_x, B_w_r, B_w_gate, B_w_up, B_w_down):
    def _A_ref(x, wqkv, w_phi, wo):
        B, S, D = x.shape
        H = 32; Dh = D // H
        qkv = (lambda x, *d: x.permute(*d))((x @ wqkv).reshape(B, S, 3, H, Dh), 2, 0, 3, 1, 4)
        q, k, v = qkv[0], qkv[1], qkv[2]
        pq = torch.einsum("bhsd,hdf->bhsf", q, w_phi)
        pk = torch.einsum("bhsd,hdf->bhsf", k, w_phi)
        phi_q = torch.concatenate([_softmax(pq, axis=-1), _softmax(-pq, axis=-1)], axis=-1)
        phi_k = torch.concatenate([_softmax(pk, axis=-1), _softmax(-pk, axis=-1)], axis=-1)
        kv = torch.einsum("bhsf,bhsd->bhfd", phi_k, v)
        z  = torch.einsum("bhsf->bhf", phi_k)
        num = torch.einsum("bhqf,bhfd->bhqd", phi_q, kv)
        den = torch.einsum("bhqf,bhf->bhq", phi_q, z)[..., None] + 1e-6
        o = num / den
        return (lambda x, *d: x.permute(*d))(o, 0, 2, 1, 3).reshape(B, S, D) @ wo

    def _B_ref(x, w_r, w_gate, w_up, w_down):
        B, S, D = x.shape
        C = 1
        r = x @ w_r
        idx = torch.argsort(-r, axis=-1)[:, :C]
        idx_e = (lambda x, n, axis: torch.repeat_interleave(x, n, dim=axis))(idx.reshape(B, C, 1), D, axis=2)
        x_sel = (lambda x, i, axis: torch.take_along_dim(x, i, dim=axis))(x, idx_e, axis=1)
        g = _silu(x_sel @ w_gate)
        u = x_sel @ w_up
        y = (g * u) @ w_down
        r_sel = _sigmoid((lambda x, i, axis: torch.take_along_dim(x, i, dim=axis))(r, idx, axis=1))
        y = y * r_sel.reshape(B, C, 1)
        b_off = (torch.arange(B) * S).reshape(B, 1)
        flat_idx = (idx + b_off).reshape(B * C)
        zero = (x * 0.0).reshape(B * S, D)
        upd = _scatter_add(zero, flat_idx, y.reshape(B * C, D), axis=0)
        return x + upd.reshape(B, S, D)

    x = A_x
    xn = _layernorm(x, axis=-1)
    return x + _A_ref(xn, A_wqkv, A_w_phi, A_wo) + _B_ref(xn, B_w_r, B_w_gate, B_w_up, B_w_down)
```

```asm
; @launch kernel=k0_kernel grid=(256,1,1) block=(320,1,1) lds=16384
; @launch kernel=k1_kernel grid=(256,1,1) block=(256,1,1) lds=158144
; @launch kernel=k2_kernel grid=(208,1,1) block=(512,1,1) lds=114688
.amdgcn_target "amdgcn-amd-amdhsa--gfx950"
.text
.globl k0_kernel
.p2align 8
.type k0_kernel,@function
k0_kernel:

    s_cmp_ge_u32 s2, 256
    s_cbranch_scc1 K0_END2
    s_load_dwordx4 s[48:51], s[0:1], 0
    s_load_dwordx2 s[52:53], s[0:1], 24
    s_load_dwordx2 s[54:55], s[0:1], 40
    s_load_dwordx2 s[56:57], s[0:1], 88
    s_load_dwordx4 s[24:27], s[0:1], 48
    s_load_dwordx2 s[28:29], s[0:1], 64
    v_and_b32 v1, 63, v0
    v_lshrrev_b32 v10, 6, v0
    s_nop 0
    v_readfirstlane_b32 s32, v10
    s_waitcnt lgkmcnt(0)
    s_mov_b32 s4, s48
    s_mov_b32 s5, s49
    s_mov_b32 s6, 2621440
    s_mov_b32 s7, 0x20000
    s_mov_b32 s8, s50
    s_mov_b32 s9, s51
    s_mov_b32 s10, 2457600
    s_mov_b32 s11, 0x20000
    s_mov_b32 s12, s52
    s_mov_b32 s13, s53
    s_mov_b32 s14, 819200
    s_mov_b32 s15, 0x20000
    s_mov_b32 s16, s54
    s_mov_b32 s17, s55
    s_mov_b32 s18, 1280
    s_mov_b32 s19, 0x20000
    s_mov_b32 s20, s56
    s_mov_b32 s21, s57
    s_mov_b32 s22, 268435456
    s_mov_b32 s23, 0x20000
    s_and_b32 s34, s2, 7
    s_lshr_b32 s35, s2, 3
    s_cmp_lt_u32 s32, 2
    s_cbranch_scc1 K0_LN
    s_cmp_eq_u32 s32, 4
    s_cbranch_scc1 K0_MISC
    s_mov_b32 s38, s2
    s_mov_b32 s39, 0
    s_cmp_eq_u32 s32, 2
    s_cbranch_scc1 K0_WB
    s_cmp_ge_u32 s2, 64
    s_cbranch_scc1 K0_END
    s_add_u32 s38, s2, 256
    s_movk_i32 s39, 8192
K0_WB:
    s_mul_i32 s40, s38, 3277
    s_lshr_b32 s40, s40, 16
    s_mul_i32 s41, s40, 20
    s_sub_u32 s41, s38, s41
    s_mul_i32 s42, s41, 122880
    s_mul_i32 s43, s40, 80
    s_add_u32 s42, s42, s43
    v_add_u32 v10, 0, v1
    v_mul_u32_u24 v11, 4370, v10
    v_lshrrev_b32 v11, 16, v11
    v_mul_u32_u24 v12, 15, v11
    v_sub_u32 v12, v10, v12
    v_mul_u32_u24 v13, 13, v12
    v_lshrrev_b32 v13, 6, v13
    v_mul_u32_u24 v14, 5, v13
    v_sub_u32 v14, v12, v14
    v_mul_u32_u24 v11, 3840, v11
    v_mul_u32_u24 v13, 1280, v13
    v_lshlrev_b32 v14, 4, v14
    v_add3_u32 v11, v11, v13, v14
    s_add_u32 m0, s39, 0
    buffer_load_dwordx4 v11, s[8:11], s42 offen lds
    v_add_u32 v10, 64, v1
    v_mul_u32_u24 v11, 4370, v10
    v_lshrrev_b32 v11, 16, v11
    v_mul_u32_u24 v12, 15, v11
    v_sub_u32 v12, v10, v12
    v_mul_u32_u24 v13, 13, v12
    v_lshrrev_b32 v13, 6, v13
    v_mul_u32_u24 v14, 5, v13
    v_sub_u32 v14, v12, v14
    v_mul_u32_u24 v11, 3840, v11
    v_mul_u32_u24 v13, 1280, v13
    v_lshlrev_b32 v14, 4, v14
    v_add3_u32 v11, v11, v13, v14
    s_add_u32 m0, s39, 1024
    buffer_load_dwordx4 v11, s[8:11], s42 offen lds
    v_add_u32 v10, 128, v1
    v_mul_u32_u24 v11, 4370, v10
    v_lshrrev_b32 v11, 16, v11
    v_mul_u32_u24 v12, 15, v11
    v_sub_u32 v12, v10, v12
    v_mul_u32_u24 v13, 13, v12
    v_lshrrev_b32 v13, 6, v13
    v_mul_u32_u24 v14, 5, v13
    v_sub_u32 v14, v12, v14
    v_mul_u32_u24 v11, 3840, v11
    v_mul_u32_u24 v13, 1280, v13
    v_lshlrev_b32 v14, 4, v14
    v_add3_u32 v11, v11, v13, v14
    s_add_u32 m0, s39, 2048
    buffer_load_dwordx4 v11, s[8:11], s42 offen lds
    v_add_u32 v10, 192, v1
    v_mul_u32_u24 v11, 4370, v10
    v_lshrrev_b32 v11, 16, v11
    v_mul_u32_u24 v12, 15, v11
    v_sub_u32 v12, v10, v12
    v_mul_u32_u24 v13, 13, v12
    v_lshrrev_b32 v13, 6, v13
    v_mul_u32_u24 v14, 5, v13
    v_sub_u32 v14, v12, v14
    v_mul_u32_u24 v11, 3840, v11
    v_mul_u32_u24 v13, 1280, v13
    v_lshlrev_b32 v14, 4, v14
    v_add3_u32 v11, v11, v13, v14
    s_add_u32 m0, s39, 3072
    buffer_load_dwordx4 v11, s[8:11], s42 offen lds
    v_add_u32 v10, 256, v1
    v_mul_u32_u24 v11, 4370, v10
    v_lshrrev_b32 v11, 16, v11
    v_mul_u32_u24 v12, 15, v11
    v_sub_u32 v12, v10, v12
    v_mul_u32_u24 v13, 13, v12
    v_lshrrev_b32 v13, 6, v13
    v_mul_u32_u24 v14, 5, v13
    v_sub_u32 v14, v12, v14
    v_mul_u32_u24 v11, 3840, v11
    v_mul_u32_u24 v13, 1280, v13
    v_lshlrev_b32 v14, 4, v14
    v_add3_u32 v11, v11, v13, v14
    s_add_u32 m0, s39, 4096
    buffer_load_dwordx4 v11, s[8:11], s42 offen lds
    v_add_u32 v10, 320, v1
    v_mul_u32_u24 v11, 4370, v10
    v_lshrrev_b32 v11, 16, v11
    v_mul_u32_u24 v12, 15, v11
    v_sub_u32 v12, v10, v12
    v_mul_u32_u24 v13, 13, v12
    v_lshrrev_b32 v13, 6, v13
    v_mul_u32_u24 v14, 5, v13
    v_sub_u32 v14, v12, v14
    v_mul_u32_u24 v11, 3840, v11
    v_mul_u32_u24 v13, 1280, v13
    v_lshlrev_b32 v14, 4, v14
    v_add3_u32 v11, v11, v13, v14
    s_add_u32 m0, s39, 5120
    buffer_load_dwordx4 v11, s[8:11], s42 offen lds
    v_add_u32 v10, 384, v1
    v_mul_u32_u24 v11, 4370, v10
    v_lshrrev_b32 v11, 16, v11
    v_mul_u32_u24 v12, 15, v11
    v_sub_u32 v12, v10, v12
    v_mul_u32_u24 v13, 13, v12
    v_lshrrev_b32 v13, 6, v13
    v_mul_u32_u24 v14, 5, v13
    v_sub_u32 v14, v12, v14
    v_mul_u32_u24 v11, 3840, v11
    v_mul_u32_u24 v13, 1280, v13
    v_lshlrev_b32 v14, 4, v14
    v_add3_u32 v11, v11, v13, v14
    s_add_u32 m0, s39, 6144
    buffer_load_dwordx4 v11, s[8:11], s42 offen lds
    v_add_u32 v10, 448, v1
    v_mul_u32_u24 v11, 4370, v10
    v_lshrrev_b32 v11, 16, v11
    v_mul_u32_u24 v12, 15, v11
    v_sub_u32 v12, v10, v12
    v_mul_u32_u24 v13, 13, v12
    v_lshrrev_b32 v13, 6, v13
    v_mul_u32_u24 v14, 5, v13
    v_sub_u32 v14, v12, v14
    v_mul_u32_u24 v11, 3840, v11
    v_mul_u32_u24 v13, 1280, v13
    v_lshlrev_b32 v14, 4, v14
    v_add3_u32 v11, v11, v13, v14
    s_add_u32 m0, s39, 7168
    s_mov_b32 exec_hi, 0
    buffer_load_dwordx4 v11, s[8:11], s42 offen lds
    s_mov_b64 exec, -1
    v_lshrrev_b32 v10, 4, v1
    v_lshlrev_b32 v10, 3, v10
    v_bfe_u32 v11, v1, 2, 2
    v_add_u32 v10, v10, v11
    v_mul_u32_u24 v10, 240, v10
    v_add_u32 v10, s39, v10
    v_and_b32 v11, 3, v1
    v_mul_u32_u24 v12, 40, v11
    v_add_u32 v12, v12, v10
    v_lshrrev_b32 v13, 1, v11
    v_mul_u32_u24 v13, 40, v13
    v_and_b32 v14, 1, v11
    v_lshlrev_b32 v14, 3, v14
    v_add3_u32 v13, v13, v14, v10
    v_add_u32 v13, 160, v13
    v_lshrrev_b32 v14, 1, v11
    v_mul_u32_u24 v14, 40, v14
    v_add_u32 v14, v14, v10
    v_add_u32 v14, 192, v14
    s_mul_i32 s42, s38, 7680
    s_add_u32 s42, s42, 12582912
    v_lshlrev_b32 v15, 4, v1
    v_lshrrev_b32 v16, 4, v1
    v_lshlrev_b32 v16, 3, v16
    v_bfe_u32 v17, v1, 3, 1
    v_lshlrev_b32 v17, 2, v17
    v_and_b32 v18, 3, v1
    v_add3_u32 v16, v16, v17, v18
    v_lshlrev_b32 v16, 4, v16
    s_waitcnt vmcnt(0)
    ds_read_b64_tr_b16 v[20:21], v12 offset:0
    ds_read_b64_tr_b16 v[22:23], v12 offset:960
    ds_read_b64_tr_b16 v[24:25], v12 offset:8
    ds_read_b64_tr_b16 v[26:27], v12 offset:968
    ds_read_b64_tr_b16 v[28:29], v12 offset:16
    ds_read_b64_tr_b16 v[30:31], v12 offset:976
    ds_read_b64_tr_b16 v[32:33], v12 offset:24
    ds_read_b64_tr_b16 v[34:35], v12 offset:984
    ds_read_b64_tr_b16 v[36:37], v12 offset:32
    ds_read_b64_tr_b16 v[38:39], v12 offset:992
    ds_read_b64_tr_b16 v[40:41], v13 offset:0
    ds_read_b64_tr_b16 v[42:43], v13 offset:960
    ds_read_b64_tr_b16 v[44:45], v13 offset:16
    ds_read_b64_tr_b16 v[46:47], v13 offset:976
    ds_read_b64_tr_b16 v[48:49], v14 offset:0
    ds_read_b64_tr_b16 v[50:51], v14 offset:960
    s_waitcnt lgkmcnt(0)
    buffer_store_dwordx4 v[20:23], v15, s[20:23], s42 offen offset:0
    buffer_store_dwordx4 v[24:27], v15, s[20:23], s42 offen offset:1024
    buffer_store_dwordx4 v[28:31], v15, s[20:23], s42 offen offset:2048
    buffer_store_dwordx4 v[32:35], v15, s[20:23], s42 offen offset:3072
    s_add_u32 s43, s42, 4096
    buffer_store_dwordx4 v[36:39], v15, s[20:23], s43 offen
    s_add_u32 s43, s42, 5120
    buffer_store_dwordx4 v[40:43], v15, s[20:23], s43 offen
    s_add_u32 s43, s42, 6144
    buffer_store_dwordx4 v[44:47], v15, s[20:23], s43 offen
    s_add_u32 s43, s42, 7168
    s_mov_b32 exec_lo, 0x0f0f0f0f
    s_mov_b32 exec_hi, 0x0f0f0f0f
    buffer_store_dwordx4 v[48:51], v16, s[20:23], s43 offen
    s_branch K0_END
K0_MISC:
    s_cmp_ge_u32 s2, 117
    s_cbranch_scc1 K0_WO
    s_lshl_b32 s38, s2, 6
    v_add_u32 v10, s38, v1
    v_lshlrev_b32 v11, 4, v10
    v_add_u32 v12, 64512, v11
    v_cmp_gt_u32 vcc, 6720, v10
    s_nop 1
    v_cndmask_b32 v11, v12, v11, vcc
    v_mov_b32 v4, 0
    v_mov_b32 v5, 0
    v_mov_b32 v6, 0
    v_mov_b32 v7, 0
    buffer_store_dwordx4 v[4:7], v11, s[20:23], 0 offen
K0_WO:
    s_cmp_ge_u32 s2, 200
    s_cbranch_scc1 K0_END
    v_and_b32 v10, 31, v1
    v_lshrrev_b32 v11, 2, v10
    v_and_b32 v11, 1, v11
    v_lshlrev_b32 v11, 4, v11
    v_lshrrev_b32 v12, 3, v10
    v_lshlrev_b32 v12, 2, v12
    v_and_b32 v13, 3, v10
    v_add3_u32 v11, v11, v12, v13
    v_lshlrev_b32 v11, 1, v11
    v_lshrrev_b32 v12, 5, v1
    v_mul_u32_u24 v12, 12800, v12
    v_add_u32 v11, v11, v12
    v_lshlrev_b32 v14, 4, v1
    s_lshl_b32 s38, s2, 2
    s_add_u32 s47, s38, 0
    s_mul_i32 s39, s47, 1639
    s_lshr_b32 s39, s39, 16
    s_mul_i32 s40, s39, 40
    s_sub_u32 s40, s47, s40
    s_mul_i32 s41, s40, 205
    s_lshr_b32 s41, s41, 10
    s_mul_i32 s42, s41, 5
    s_sub_u32 s42, s40, s42
    s_mul_i32 s43, s41, 80
    s_lshl_b32 s64, s42, 3
    s_lshl_b32 s65, s39, 6
    s_add_u32 s66, s64, 0
    s_mul_i32 s67, s66, 205
    s_lshr_b32 s67, s67, 11
    s_mul_i32 s67, s67, 10
    s_add_u32 s66, s66, s67
    s_add_u32 s66, s66, s43
    s_mul_i32 s66, s66, 1280
    s_add_u32 s66, s66, s65
    buffer_load_ushort v16, v11, s[12:15], s66 offen
    s_add_u32 s66, s64, 1
    s_mul_i32 s67, s66, 205
    s_lshr_b32 s67, s67, 11
    s_mul_i32 s67, s67, 10
    s_add_u32 s66, s66, s67
    s_add_u32 s66, s66, s43
    s_mul_i32 s66, s66, 1280
    s_add_u32 s66, s66, s65
    buffer_load_ushort v17, v11, s[12:15], s66 offen
    s_add_u32 s66, s64, 2
    s_mul_i32 s67, s66, 205
    s_lshr_b32 s67, s67, 11
    s_mul_i32 s67, s67, 10
    s_add_u32 s66, s66, s67
    s_add_u32 s66, s66, s43
    s_mul_i32 s66, s66, 1280
    s_add_u32 s66, s66, s65
    buffer_load_ushort v18, v11, s[12:15], s66 offen
    s_add_u32 s66, s64, 3
    s_mul_i32 s67, s66, 205
    s_lshr_b32 s67, s67, 11
    s_mul_i32 s67, s67, 10
    s_add_u32 s66, s66, s67
    s_add_u32 s66, s66, s43
    s_mul_i32 s66, s66, 1280
    s_add_u32 s66, s66, s65
    buffer_load_ushort v19, v11, s[12:15], s66 offen
    s_add_u32 s66, s64, 4
    s_mul_i32 s67, s66, 205
    s_lshr_b32 s67, s67, 11
    s_mul_i32 s67, s67, 10
    s_add_u32 s66, s66, s67
    s_add_u32 s66, s66, s43
    s_mul_i32 s66, s66, 1280
    s_add_u32 s66, s66, s65
    buffer_load_ushort v20, v11, s[12:15], s66 offen
    s_add_u32 s66, s64, 5
    s_mul_i32 s67, s66, 205
    s_lshr_b32 s67, s67, 11
    s_mul_i32 s67, s67, 10
    s_add_u32 s66, s66, s67
    s_add_u32 s66, s66, s43
    s_mul_i32 s66, s66, 1280
    s_add_u32 s66, s66, s65
    buffer_load_ushort v21, v11, s[12:15], s66 offen
    s_add_u32 s66, s64, 6
    s_mul_i32 s67, s66, 205
    s_lshr_b32 s67, s67, 11
    s_mul_i32 s67, s67, 10
    s_add_u32 s66, s66, s67
    s_add_u32 s66, s66, s43
    s_mul_i32 s66, s66, 1280
    s_add_u32 s66, s66, s65
    buffer_load_ushort v22, v11, s[12:15], s66 offen
    s_add_u32 s66, s64, 7
    s_mul_i32 s67, s66, 205
    s_lshr_b32 s67, s67, 11
    s_mul_i32 s67, s67, 10
    s_add_u32 s66, s66, s67
    s_add_u32 s66, s66, s43
    s_mul_i32 s66, s66, 1280
    s_add_u32 s66, s66, s65
    buffer_load_ushort v23, v11, s[12:15], s66 offen
    s_add_u32 s47, s38, 1
    s_mul_i32 s39, s47, 1639
    s_lshr_b32 s39, s39, 16
    s_mul_i32 s40, s39, 40
    s_sub_u32 s40, s47, s40
    s_mul_i32 s41, s40, 205
    s_lshr_b32 s41, s41, 10
    s_mul_i32 s42, s41, 5
    s_sub_u32 s42, s40, s42
    s_mul_i32 s43, s41, 80
    s_lshl_b32 s64, s42, 3
    s_lshl_b32 s65, s39, 6
    s_add_u32 s66, s64, 0
    s_mul_i32 s67, s66, 205
    s_lshr_b32 s67, s67, 11
    s_mul_i32 s67, s67, 10
    s_add_u32 s66, s66, s67
    s_add_u32 s66, s66, s43
    s_mul_i32 s66, s66, 1280
    s_add_u32 s66, s66, s65
    buffer_load_ushort v24, v11, s[12:15], s66 offen
    s_add_u32 s66, s64, 1
    s_mul_i32 s67, s66, 205
    s_lshr_b32 s67, s67, 11
    s_mul_i32 s67, s67, 10
    s_add_u32 s66, s66, s67
    s_add_u32 s66, s66, s43
    s_mul_i32 s66, s66, 1280
    s_add_u32 s66, s66, s65
    buffer_load_ushort v25, v11, s[12:15], s66 offen
    s_add_u32 s66, s64, 2
    s_mul_i32 s67, s66, 205
    s_lshr_b32 s67, s67, 11
    s_mul_i32 s67, s67, 10
    s_add_u32 s66, s66, s67
    s_add_u32 s66, s66, s43
    s_mul_i32 s66, s66, 1280
    s_add_u32 s66, s66, s65
    buffer_load_ushort v26, v11, s[12:15], s66 offen
    s_add_u32 s66, s64, 3
    s_mul_i32 s67, s66, 205
    s_lshr_b32 s67, s67, 11
    s_mul_i32 s67, s67, 10
    s_add_u32 s66, s66, s67
    s_add_u32 s66, s66, s43
    s_mul_i32 s66, s66, 1280
    s_add_u32 s66, s66, s65
    buffer_load_ushort v27, v11, s[12:15], s66 offen
    s_add_u32 s66, s64, 4
    s_mul_i32 s67, s66, 205
    s_lshr_b32 s67, s67, 11
    s_mul_i32 s67, s67, 10
    s_add_u32 s66, s66, s67
    s_add_u32 s66, s66, s43
    s_mul_i32 s66, s66, 1280
    s_add_u32 s66, s66, s65
    buffer_load_ushort v28, v11, s[12:15], s66 offen
    s_add_u32 s66, s64, 5
    s_mul_i32 s67, s66, 205
    s_lshr_b32 s67, s67, 11
    s_mul_i32 s67, s67, 10
    s_add_u32 s66, s66, s67
    s_add_u32 s66, s66, s43
    s_mul_i32 s66, s66, 1280
    s_add_u32 s66, s66, s65
    buffer_load_ushort v29, v11, s[12:15], s66 offen
    s_add_u32 s66, s64, 6
    s_mul_i32 s67, s66, 205
    s_lshr_b32 s67, s67, 11
    s_mul_i32 s67, s67, 10
    s_add_u32 s66, s66, s67
    s_add_u32 s66, s66, s43
    s_mul_i32 s66, s66, 1280
    s_add_u32 s66, s66, s65
    buffer_load_ushort v30, v11, s[12:15], s66 offen
    s_add_u32 s66, s64, 7
    s_mul_i32 s67, s66, 205
    s_lshr_b32 s67, s67, 11
    s_mul_i32 s67, s67, 10
    s_add_u32 s66, s66, s67
    s_add_u32 s66, s66, s43
    s_mul_i32 s66, s66, 1280
    s_add_u32 s66, s66, s65
    buffer_load_ushort v31, v11, s[12:15], s66 offen
    s_add_u32 s47, s38, 2
    s_mul_i32 s39, s47, 1639
    s_lshr_b32 s39, s39, 16
    s_mul_i32 s40, s39, 40
    s_sub_u32 s40, s47, s40
    s_mul_i32 s41, s40, 205
    s_lshr_b32 s41, s41, 10
    s_mul_i32 s42, s41, 5
    s_sub_u32 s42, s40, s42
    s_mul_i32 s43, s41, 80
    s_lshl_b32 s64, s42, 3
    s_lshl_b32 s65, s39, 6
    s_add_u32 s66, s64, 0
    s_mul_i32 s67, s66, 205
    s_lshr_b32 s67, s67, 11
    s_mul_i32 s67, s67, 10
    s_add_u32 s66, s66, s67
    s_add_u32 s66, s66, s43
    s_mul_i32 s66, s66, 1280
    s_add_u32 s66, s66, s65
    buffer_load_ushort v32, v11, s[12:15], s66 offen
    s_add_u32 s66, s64, 1
    s_mul_i32 s67, s66, 205
    s_lshr_b32 s67, s67, 11
    s_mul_i32 s67, s67, 10
    s_add_u32 s66, s66, s67
    s_add_u32 s66, s66, s43
    s_mul_i32 s66, s66, 1280
    s_add_u32 s66, s66, s65
    buffer_load_ushort v33, v11, s[12:15], s66 offen
    s_add_u32 s66, s64, 2
    s_mul_i32 s67, s66, 205
    s_lshr_b32 s67, s67, 11
    s_mul_i32 s67, s67, 10
    s_add_u32 s66, s66, s67
    s_add_u32 s66, s66, s43
    s_mul_i32 s66, s66, 1280
    s_add_u32 s66, s66, s65
    buffer_load_ushort v34, v11, s[12:15], s66 offen
    s_add_u32 s66, s64, 3
    s_mul_i32 s67, s66, 205
    s_lshr_b32 s67, s67, 11
    s_mul_i32 s67, s67, 10
    s_add_u32 s66, s66, s67
    s_add_u32 s66, s66, s43
    s_mul_i32 s66, s66, 1280
    s_add_u32 s66, s66, s65
    buffer_load_ushort v35, v11, s[12:15], s66 offen
    s_add_u32 s66, s64, 4
    s_mul_i32 s67, s66, 205
    s_lshr_b32 s67, s67, 11
    s_mul_i32 s67, s67, 10
    s_add_u32 s66, s66, s67
    s_add_u32 s66, s66, s43
    s_mul_i32 s66, s66, 1280
    s_add_u32 s66, s66, s65
    buffer_load_ushort v36, v11, s[12:15], s66 offen
    s_add_u32 s66, s64, 5
    s_mul_i32 s67, s66, 205
    s_lshr_b32 s67, s67, 11
    s_mul_i32 s67, s67, 10
    s_add_u32 s66, s66, s67
    s_add_u32 s66, s66, s43
    s_mul_i32 s66, s66, 1280
    s_add_u32 s66, s66, s65
    buffer_load_ushort v37, v11, s[12:15], s66 offen
    s_add_u32 s66, s64, 6
    s_mul_i32 s67, s66, 205
    s_lshr_b32 s67, s67, 11
    s_mul_i32 s67, s67, 10
    s_add_u32 s66, s66, s67
    s_add_u32 s66, s66, s43
    s_mul_i32 s66, s66, 1280
    s_add_u32 s66, s66, s65
    buffer_load_ushort v38, v11, s[12:15], s66 offen
    s_add_u32 s66, s64, 7
    s_mul_i32 s67, s66, 205
    s_lshr_b32 s67, s67, 11
    s_mul_i32 s67, s67, 10
    s_add_u32 s66, s66, s67
    s_add_u32 s66, s66, s43
    s_mul_i32 s66, s66, 1280
    s_add_u32 s66, s66, s65
    buffer_load_ushort v39, v11, s[12:15], s66 offen
    s_add_u32 s47, s38, 3
    s_mul_i32 s39, s47, 1639
    s_lshr_b32 s39, s39, 16
    s_mul_i32 s40, s39, 40
    s_sub_u32 s40, s47, s40
    s_mul_i32 s41, s40, 205
    s_lshr_b32 s41, s41, 10
    s_mul_i32 s42, s41, 5
    s_sub_u32 s42, s40, s42
    s_mul_i32 s43, s41, 80
    s_lshl_b32 s64, s42, 3
    s_lshl_b32 s65, s39, 6
    s_add_u32 s66, s64, 0
    s_mul_i32 s67, s66, 205
    s_lshr_b32 s67, s67, 11
    s_mul_i32 s67, s67, 10
    s_add_u32 s66, s66, s67
    s_add_u32 s66, s66, s43
    s_mul_i32 s66, s66, 1280
    s_add_u32 s66, s66, s65
    buffer_load_ushort v40, v11, s[12:15], s66 offen
    s_add_u32 s66, s64, 1
    s_mul_i32 s67, s66, 205
    s_lshr_b32 s67, s67, 11
    s_mul_i32 s67, s67, 10
    s_add_u32 s66, s66, s67
    s_add_u32 s66, s66, s43
    s_mul_i32 s66, s66, 1280
    s_add_u32 s66, s66, s65
    buffer_load_ushort v41, v11, s[12:15], s66 offen
    s_add_u32 s66, s64, 2
    s_mul_i32 s67, s66, 205
    s_lshr_b32 s67, s67, 11
    s_mul_i32 s67, s67, 10
    s_add_u32 s66, s66, s67
    s_add_u32 s66, s66, s43
    s_mul_i32 s66, s66, 1280
    s_add_u32 s66, s66, s65
    buffer_load_ushort v42, v11, s[12:15], s66 offen
    s_add_u32 s66, s64, 3
    s_mul_i32 s67, s66, 205
    s_lshr_b32 s67, s67, 11
    s_mul_i32 s67, s67, 10
    s_add_u32 s66, s66, s67
    s_add_u32 s66, s66, s43
    s_mul_i32 s66, s66, 1280
    s_add_u32 s66, s66, s65
    buffer_load_ushort v43, v11, s[12:15], s66 offen
    s_add_u32 s66, s64, 4
    s_mul_i32 s67, s66, 205
    s_lshr_b32 s67, s67, 11
    s_mul_i32 s67, s67, 10
    s_add_u32 s66, s66, s67
    s_add_u32 s66, s66, s43
    s_mul_i32 s66, s66, 1280
    s_add_u32 s66, s66, s65
    buffer_load_ushort v44, v11, s[12:15], s66 offen
    s_add_u32 s66, s64, 5
    s_mul_i32 s67, s66, 205
    s_lshr_b32 s67, s67, 11
    s_mul_i32 s67, s67, 10
    s_add_u32 s66, s66, s67
    s_add_u32 s66, s66, s43
    s_mul_i32 s66, s66, 1280
    s_add_u32 s66, s66, s65
    buffer_load_ushort v45, v11, s[12:15], s66 offen
    s_add_u32 s66, s64, 6
    s_mul_i32 s67, s66, 205
    s_lshr_b32 s67, s67, 11
    s_mul_i32 s67, s67, 10
    s_add_u32 s66, s66, s67
    s_add_u32 s66, s66, s43
    s_mul_i32 s66, s66, 1280
    s_add_u32 s66, s66, s65
    buffer_load_ushort v46, v11, s[12:15], s66 offen
    s_add_u32 s66, s64, 7
    s_mul_i32 s67, s66, 205
    s_lshr_b32 s67, s67, 11
    s_mul_i32 s67, s67, 10
    s_add_u32 s66, s66, s67
    s_add_u32 s66, s66, s43
    s_mul_i32 s66, s66, 1280
    s_add_u32 s66, s66, s65
    buffer_load_ushort v47, v11, s[12:15], s66 offen
    s_waitcnt vmcnt(0)
    v_lshl_or_b32 v48, v17, 16, v16
    v_lshl_or_b32 v49, v19, 16, v18
    v_lshl_or_b32 v50, v21, 16, v20
    v_lshl_or_b32 v51, v23, 16, v22
    s_add_u32 s47, s38, 0
    s_lshl_b32 s47, s47, 10
    s_add_u32 s47, s47, 1048576
    buffer_store_dwordx4 v[48:51], v14, s[20:23], s47 offen
    v_lshl_or_b32 v52, v25, 16, v24
    v_lshl_or_b32 v53, v27, 16, v26
    v_lshl_or_b32 v54, v29, 16, v28
    v_lshl_or_b32 v55, v31, 16, v30
    s_add_u32 s47, s38, 1
    s_lshl_b32 s47, s47, 10
    s_add_u32 s47, s47, 1048576
    buffer_store_dwordx4 v[52:55], v14, s[20:23], s47 offen
    v_lshl_or_b32 v56, v33, 16, v32
    v_lshl_or_b32 v57, v35, 16, v34
    v_lshl_or_b32 v58, v37, 16, v36
    v_lshl_or_b32 v59, v39, 16, v38
    s_add_u32 s47, s38, 2
    s_lshl_b32 s47, s47, 10
    s_add_u32 s47, s47, 1048576
    buffer_store_dwordx4 v[56:59], v14, s[20:23], s47 offen
    v_lshl_or_b32 v60, v41, 16, v40
    v_lshl_or_b32 v61, v43, 16, v42
    v_lshl_or_b32 v62, v45, 16, v44
    v_lshl_or_b32 v63, v47, 16, v46
    s_add_u32 s47, s38, 3
    s_lshl_b32 s47, s47, 10
    s_add_u32 s47, s47, 1048576
    buffer_store_dwordx4 v[60:63], v14, s[20:23], s47 offen
    s_branch K0_END
K0_TOUCH:
    s_cmp_ge_u32 s35, 24
    s_cbranch_scc1 K0_END
    s_mov_b32 s68, s24
    s_mov_b32 s69, s25
    s_mov_b32 s70, 1966080
    s_mov_b32 s71, 0x20000
    s_mov_b32 s72, s26
    s_mov_b32 s73, s27
    s_mov_b32 s74, 1966080
    s_mov_b32 s75, 0x20000
    s_mov_b32 s76, s28
    s_mov_b32 s77, s29
    s_mov_b32 s78, 1966080
    s_mov_b32 s79, 0x20000
    s_lshr_b32 s42, s35, 2
    s_lshl_b32 s42, s42, 3
    s_add_u32 s42, s42, s34
    s_and_b32 s43, s35, 3
    s_mul_i32 s46, s43, 160
    v_lshrrev_b32 v10, 2, v1
    v_add_u32 v10, s46, v10
    s_movk_i32 s47, 3072
    v_mul_lo_u32 v10, v10, s47
    v_and_b32 v11, 3, v1
    v_lshlrev_b32 v11, 4, v11
    s_lshl_b32 s47, s42, 6
    v_add3_u32 v10, v10, v11, s47
    v_lshlrev_b32 v12, 4, v1
    s_mov_b32 s47, 0
    buffer_load_dwordx4 v[16:19], v10, s[68:71], s47 offen
    buffer_load_dwordx4 v[20:23], v10, s[72:75], s47 offen
    s_mov_b32 s47, 49152
    buffer_load_dwordx4 v[16:19], v10, s[68:71], s47 offen
    buffer_load_dwordx4 v[20:23], v10, s[72:75], s47 offen
    s_mov_b32 s47, 98304
    buffer_load_dwordx4 v[16:19], v10, s[68:71], s47 offen
    buffer_load_dwordx4 v[20:23], v10, s[72:75], s47 offen
    s_mov_b32 s47, 147456
    buffer_load_dwordx4 v[16:19], v10, s[68:71], s47 offen
    buffer_load_dwordx4 v[20:23], v10, s[72:75], s47 offen
    s_mov_b32 s47, 196608
    buffer_load_dwordx4 v[16:19], v10, s[68:71], s47 offen
    buffer_load_dwordx4 v[20:23], v10, s[72:75], s47 offen
    s_mov_b32 s47, 245760
    buffer_load_dwordx4 v[16:19], v10, s[68:71], s47 offen
    buffer_load_dwordx4 v[20:23], v10, s[72:75], s47 offen
    s_mov_b32 s47, 294912
    buffer_load_dwordx4 v[16:19], v10, s[68:71], s47 offen
    buffer_load_dwordx4 v[20:23], v10, s[72:75], s47 offen
    s_mov_b32 s47, 344064
    buffer_load_dwordx4 v[16:19], v10, s[68:71], s47 offen
    buffer_load_dwordx4 v[20:23], v10, s[72:75], s47 offen
    s_mov_b32 s47, 393216
    buffer_load_dwordx4 v[16:19], v10, s[68:71], s47 offen
    buffer_load_dwordx4 v[20:23], v10, s[72:75], s47 offen
    s_mov_b32 s47, 442368
    buffer_load_dwordx4 v[16:19], v10, s[68:71], s47 offen
    buffer_load_dwordx4 v[20:23], v10, s[72:75], s47 offen
    s_lshl_b32 s46, s42, 5
    s_lshl_b32 s47, s43, 3
    s_add_u32 s46, s46, s47
    s_mul_i32 s46, s46, 1280
    s_add_u32 s47, s46, 0
    buffer_load_dwordx4 v[24:27], v12, s[76:79], s47 offen
    s_add_u32 s47, s46, 1024
    buffer_load_dwordx4 v[24:27], v12, s[76:79], s47 offen
    s_add_u32 s47, s46, 2048
    buffer_load_dwordx4 v[24:27], v12, s[76:79], s47 offen
    s_add_u32 s47, s46, 3072
    buffer_load_dwordx4 v[24:27], v12, s[76:79], s47 offen
    s_add_u32 s47, s46, 4096
    buffer_load_dwordx4 v[24:27], v12, s[76:79], s47 offen
    s_add_u32 s47, s46, 5120
    buffer_load_dwordx4 v[24:27], v12, s[76:79], s47 offen
    s_add_u32 s47, s46, 6144
    buffer_load_dwordx4 v[24:27], v12, s[76:79], s47 offen
    s_add_u32 s47, s46, 7168
    buffer_load_dwordx4 v[24:27], v12, s[76:79], s47 offen
    s_add_u32 s47, s46, 8192
    buffer_load_dwordx4 v[24:27], v12, s[76:79], s47 offen
    s_add_u32 s47, s46, 9216
    buffer_load_dwordx4 v[24:27], v12, s[76:79], s47 offen
    s_branch K0_END
K0_LN:
    s_lshl_b32 s38, s2, 3
    s_lshl_b32 s39, s32, 2
    s_add_u32 s38, s38, s39
    v_lshrrev_b32 v10, 4, v1
    v_add_u32 v10, s38, v10
    s_movk_i32 s39, 1280
    v_mul_lo_u32 v11, v10, s39
    v_and_b32 v12, 15, v1
    v_lshlrev_b32 v13, 4, v12
    v_add_u32 v11, v11, v13
    buffer_load_dwordx4 v[16:19], v11, s[4:7], 0 offen offset:0
    buffer_load_dwordx4 v[20:23], v11, s[4:7], 0 offen offset:256
    buffer_load_dwordx4 v[24:27], v11, s[4:7], 0 offen offset:512
    buffer_load_dwordx4 v[28:31], v11, s[4:7], 0 offen offset:768
    buffer_load_dwordx4 v[32:35], v11, s[4:7], 0 offen offset:1024
    buffer_load_dwordx4 v[36:39], v13, s[16:19], 0 offen offset:0
    buffer_load_dwordx4 v[40:43], v13, s[16:19], 0 offen offset:256
    buffer_load_dwordx4 v[44:47], v13, s[16:19], 0 offen offset:512
    buffer_load_dwordx4 v[48:51], v13, s[16:19], 0 offen offset:768
    buffer_load_dwordx4 v[52:55], v13, s[16:19], 0 offen offset:1024
    s_mov_b32 s60, 0x3f803f80
    s_mov_b32 s61, 0x00003f80
    s_mov_b32 s62, 0x3f800000
    v_mov_b32 v2, 0
    v_mov_b32 v3, 0
    s_waitcnt vmcnt(5)
    v_dot2_f32_bf16 v2, v16, s60, v2
    v_dot2_f32_bf16 v3, v16, v16, v3
    v_dot2_f32_bf16 v2, v17, s60, v2
    v_dot2_f32_bf16 v3, v17, v17, v3
    v_dot2_f32_bf16 v2, v18, s60, v2
    v_dot2_f32_bf16 v3, v18, v18, v3
    v_dot2_f32_bf16 v2, v19, s60, v2
    v_dot2_f32_bf16 v3, v19, v19, v3
    v_dot2_f32_bf16 v2, v20, s60, v2
    v_dot2_f32_bf16 v3, v20, v20, v3
    v_dot2_f32_bf16 v2, v21, s60, v2
    v_dot2_f32_bf16 v3, v21, v21, v3
    v_dot2_f32_bf16 v2, v22, s60, v2
    v_dot2_f32_bf16 v3, v22, v22, v3
    v_dot2_f32_bf16 v2, v23, s60, v2
    v_dot2_f32_bf16 v3, v23, v23, v3
    v_dot2_f32_bf16 v2, v24, s60, v2
    v_dot2_f32_bf16 v3, v24, v24, v3
    v_dot2_f32_bf16 v2, v25, s60, v2
    v_dot2_f32_bf16 v3, v25, v25, v3
    v_dot2_f32_bf16 v2, v26, s60, v2
    v_dot2_f32_bf16 v3, v26, v26, v3
    v_dot2_f32_bf16 v2, v27, s60, v2
    v_dot2_f32_bf16 v3, v27, v27, v3
    v_dot2_f32_bf16 v2, v28, s60, v2
    v_dot2_f32_bf16 v3, v28, v28, v3
    v_dot2_f32_bf16 v2, v29, s60, v2
    v_dot2_f32_bf16 v3, v29, v29, v3
    v_dot2_f32_bf16 v2, v30, s60, v2
    v_dot2_f32_bf16 v3, v30, v30, v3
    v_dot2_f32_bf16 v2, v31, s60, v2
    v_dot2_f32_bf16 v3, v31, v31, v3
    v_dot2_f32_bf16 v2, v32, s60, v2
    v_dot2_f32_bf16 v3, v32, v32, v3
    v_dot2_f32_bf16 v2, v33, s60, v2
    v_dot2_f32_bf16 v3, v33, v33, v3
    v_dot2_f32_bf16 v2, v34, s60, v2
    v_dot2_f32_bf16 v3, v34, v34, v3
    v_dot2_f32_bf16 v2, v35, s60, v2
    v_dot2_f32_bf16 v3, v35, v35, v3
    s_nop 3
    v_add_f32_dpp v2, v2, v2 row_ror:1 row_mask:0xf bank_mask:0xf
    v_add_f32_dpp v3, v3, v3 row_ror:1 row_mask:0xf bank_mask:0xf
    s_nop 1
    v_add_f32_dpp v2, v2, v2 row_ror:2 row_mask:0xf bank_mask:0xf
    v_add_f32_dpp v3, v3, v3 row_ror:2 row_mask:0xf bank_mask:0xf
    s_nop 1
    v_add_f32_dpp v2, v2, v2 row_ror:4 row_mask:0xf bank_mask:0xf
    v_add_f32_dpp v3, v3, v3 row_ror:4 row_mask:0xf bank_mask:0xf
    s_nop 1
    v_add_f32_dpp v2, v2, v2 row_ror:8 row_mask:0xf bank_mask:0xf
    v_add_f32_dpp v3, v3, v3 row_ror:8 row_mask:0xf bank_mask:0xf
    s_nop 1
    v_mul_f32 v2, 0x3acccccd, v2
    v_mul_f32 v3, 0x3acccccd, v3
    v_fma_f32 v3, -v2, v2, v3
    v_max_f32 v3, 0, v3
    v_cvt_pk_bf16_f32 v4, v2, v3
    v_lshlrev_b32 v6, 16, v4
    v_and_b32 v5, 0xffff0000, v4
    v_add_f32 v5, 0x3727c5ac, v5
    v_cvt_pk_bf16_f32 v5, v5, v5
    v_and_b32 v5, 0xffff0000, v5
    v_sqrt_f32 v5, v5
    s_nop 0
    v_cvt_pk_bf16_f32 v5, v5, v5
    v_and_b32 v5, 0xffff0000, v5
    v_rcp_f32 v7, v5
    v_sub_f32 v8, 0, v6
    s_nop 0
    v_dot2_f32_bf16 v56, v16, s61, v8
    v_dot2_f32_bf16 v57, v16, s62, v8
    s_nop 2
    v_cvt_pk_bf16_f32 v58, v56, v57
    v_lshlrev_b32 v56, 16, v58
    v_and_b32 v57, 0xffff0000, v58
    v_mul_f32 v56, v56, v7
    v_mul_f32 v57, v57, v7
    v_cvt_pk_bf16_f32 v16, v56, v57
    v_dot2_f32_bf16 v56, v17, s61, v8
    v_dot2_f32_bf16 v57, v17, s62, v8
    s_nop 2
    v_cvt_pk_bf16_f32 v58, v56, v57
    v_lshlrev_b32 v56, 16, v58
    v_and_b32 v57, 0xffff0000, v58
    v_mul_f32 v56, v56, v7
    v_mul_f32 v57, v57, v7
    v_cvt_pk_bf16_f32 v17, v56, v57
    v_dot2_f32_bf16 v56, v18, s61, v8
    v_dot2_f32_bf16 v57, v18, s62, v8
    s_nop 2
    v_cvt_pk_bf16_f32 v58, v56, v57
    v_lshlrev_b32 v56, 16, v58
    v_and_b32 v57, 0xffff0000, v58
    v_mul_f32 v56, v56, v7
    v_mul_f32 v57, v57, v7
    v_cvt_pk_bf16_f32 v18, v56, v57
    v_dot2_f32_bf16 v56, v19, s61, v8
    v_dot2_f32_bf16 v57, v19, s62, v8
    s_nop 2
    v_cvt_pk_bf16_f32 v58, v56, v57
    v_lshlrev_b32 v56, 16, v58
    v_and_b32 v57, 0xffff0000, v58
    v_mul_f32 v56, v56, v7
    v_mul_f32 v57, v57, v7
    v_cvt_pk_bf16_f32 v19, v56, v57
    v_dot2_f32_bf16 v56, v20, s61, v8
    v_dot2_f32_bf16 v57, v20, s62, v8
    s_nop 2
    v_cvt_pk_bf16_f32 v58, v56, v57
    v_lshlrev_b32 v56, 16, v58
    v_and_b32 v57, 0xffff0000, v58
    v_mul_f32 v56, v56, v7
    v_mul_f32 v57, v57, v7
    v_cvt_pk_bf16_f32 v20, v56, v57
    v_dot2_f32_bf16 v56, v21, s61, v8
    v_dot2_f32_bf16 v57, v21, s62, v8
    s_nop 2
    v_cvt_pk_bf16_f32 v58, v56, v57
    v_lshlrev_b32 v56, 16, v58
    v_and_b32 v57, 0xffff0000, v58
    v_mul_f32 v56, v56, v7
    v_mul_f32 v57, v57, v7
    v_cvt_pk_bf16_f32 v21, v56, v57
    v_dot2_f32_bf16 v56, v22, s61, v8
    v_dot2_f32_bf16 v57, v22, s62, v8
    s_nop 2
    v_cvt_pk_bf16_f32 v58, v56, v57
    v_lshlrev_b32 v56, 16, v58
    v_and_b32 v57, 0xffff0000, v58
    v_mul_f32 v56, v56, v7
    v_mul_f32 v57, v57, v7
    v_cvt_pk_bf16_f32 v22, v56, v57
    v_dot2_f32_bf16 v56, v23, s61, v8
    v_dot2_f32_bf16 v57, v23, s62, v8
    s_nop 2
    v_cvt_pk_bf16_f32 v58, v56, v57
    v_lshlrev_b32 v56, 16, v58
    v_and_b32 v57, 0xffff0000, v58
    v_mul_f32 v56, v56, v7
    v_mul_f32 v57, v57, v7
    v_cvt_pk_bf16_f32 v23, v56, v57
    v_dot2_f32_bf16 v56, v24, s61, v8
    v_dot2_f32_bf16 v57, v24, s62, v8
    s_nop 2
    v_cvt_pk_bf16_f32 v58, v56, v57
    v_lshlrev_b32 v56, 16, v58
    v_and_b32 v57, 0xffff0000, v58
    v_mul_f32 v56, v56, v7
    v_mul_f32 v57, v57, v7
    v_cvt_pk_bf16_f32 v24, v56, v57
    v_dot2_f32_bf16 v56, v25, s61, v8
    v_dot2_f32_bf16 v57, v25, s62, v8
    s_nop 2
    v_cvt_pk_bf16_f32 v58, v56, v57
    v_lshlrev_b32 v56, 16, v58
    v_and_b32 v57, 0xffff0000, v58
    v_mul_f32 v56, v56, v7
    v_mul_f32 v57, v57, v7
    v_cvt_pk_bf16_f32 v25, v56, v57
    v_dot2_f32_bf16 v56, v26, s61, v8
    v_dot2_f32_bf16 v57, v26, s62, v8
    s_nop 2
    v_cvt_pk_bf16_f32 v58, v56, v57
    v_lshlrev_b32 v56, 16, v58
    v_and_b32 v57, 0xffff0000, v58
    v_mul_f32 v56, v56, v7
    v_mul_f32 v57, v57, v7
    v_cvt_pk_bf16_f32 v26, v56, v57
    v_dot2_f32_bf16 v56, v27, s61, v8
    v_dot2_f32_bf16 v57, v27, s62, v8
    s_nop 2
    v_cvt_pk_bf16_f32 v58, v56, v57
    v_lshlrev_b32 v56, 16, v58
    v_and_b32 v57, 0xffff0000, v58
    v_mul_f32 v56, v56, v7
    v_mul_f32 v57, v57, v7
    v_cvt_pk_bf16_f32 v27, v56, v57
    v_dot2_f32_bf16 v56, v28, s61, v8
    v_dot2_f32_bf16 v57, v28, s62, v8
    s_nop 2
    v_cvt_pk_bf16_f32 v58, v56, v57
    v_lshlrev_b32 v56, 16, v58
    v_and_b32 v57, 0xffff0000, v58
    v_mul_f32 v56, v56, v7
    v_mul_f32 v57, v57, v7
    v_cvt_pk_bf16_f32 v28, v56, v57
    v_dot2_f32_bf16 v56, v29, s61, v8
    v_dot2_f32_bf16 v57, v29, s62, v8
    s_nop 2
    v_cvt_pk_bf16_f32 v58, v56, v57
    v_lshlrev_b32 v56, 16, v58
    v_and_b32 v57, 0xffff0000, v58
    v_mul_f32 v56, v56, v7
    v_mul_f32 v57, v57, v7
    v_cvt_pk_bf16_f32 v29, v56, v57
    v_dot2_f32_bf16 v56, v30, s61, v8
    v_dot2_f32_bf16 v57, v30, s62, v8
    s_nop 2
    v_cvt_pk_bf16_f32 v58, v56, v57
    v_lshlrev_b32 v56, 16, v58
    v_and_b32 v57, 0xffff0000, v58
    v_mul_f32 v56, v56, v7
    v_mul_f32 v57, v57, v7
    v_cvt_pk_bf16_f32 v30, v56, v57
    v_dot2_f32_bf16 v56, v31, s61, v8
    v_dot2_f32_bf16 v57, v31, s62, v8
    s_nop 2
    v_cvt_pk_bf16_f32 v58, v56, v57
    v_lshlrev_b32 v56, 16, v58
    v_and_b32 v57, 0xffff0000, v58
    v_mul_f32 v56, v56, v7
    v_mul_f32 v57, v57, v7
    v_cvt_pk_bf16_f32 v31, v56, v57
    v_dot2_f32_bf16 v56, v32, s61, v8
    v_dot2_f32_bf16 v57, v32, s62, v8
    s_nop 2
    v_cvt_pk_bf16_f32 v58, v56, v57
    v_lshlrev_b32 v56, 16, v58
    v_and_b32 v57, 0xffff0000, v58
    v_mul_f32 v56, v56, v7
    v_mul_f32 v57, v57, v7
    v_cvt_pk_bf16_f32 v32, v56, v57
    v_dot2_f32_bf16 v56, v33, s61, v8
    v_dot2_f32_bf16 v57, v33, s62, v8
    s_nop 2
    v_cvt_pk_bf16_f32 v58, v56, v57
    v_lshlrev_b32 v56, 16, v58
    v_and_b32 v57, 0xffff0000, v58
    v_mul_f32 v56, v56, v7
    v_mul_f32 v57, v57, v7
    v_cvt_pk_bf16_f32 v33, v56, v57
    v_dot2_f32_bf16 v56, v34, s61, v8
    v_dot2_f32_bf16 v57, v34, s62, v8
    s_nop 2
    v_cvt_pk_bf16_f32 v58, v56, v57
    v_lshlrev_b32 v56, 16, v58
    v_and_b32 v57, 0xffff0000, v58
    v_mul_f32 v56, v56, v7
    v_mul_f32 v57, v57, v7
    v_cvt_pk_bf16_f32 v34, v56, v57
    v_dot2_f32_bf16 v56, v35, s61, v8
    v_dot2_f32_bf16 v57, v35, s62, v8
    s_nop 2
    v_cvt_pk_bf16_f32 v58, v56, v57
    v_lshlrev_b32 v56, 16, v58
    v_and_b32 v57, 0xffff0000, v58
    v_mul_f32 v56, v56, v7
    v_mul_f32 v57, v57, v7
    v_cvt_pk_bf16_f32 v35, v56, v57
    v_lshrrev_b32 v2, 4, v10
    v_mul_u32_u24 v2, 20480, v2
    v_lshrrev_b32 v3, 2, v12
    v_lshlrev_b32 v3, 10, v3
    v_and_b32 v4, 3, v12
    v_lshlrev_b32 v4, 8, v4
    v_and_b32 v5, 15, v10
    v_lshlrev_b32 v5, 4, v5
    v_add3_u32 v2, v2, v3, v4
    v_add_u32 v2, v2, v5
    s_mov_b32 s39, 8388608
    s_add_u32 s40, s39, 0
    buffer_store_dwordx4 v[16:19], v2, s[20:23], s40 offen
    s_add_u32 s40, s39, 4096
    buffer_store_dwordx4 v[20:23], v2, s[20:23], s40 offen
    s_add_u32 s40, s39, 8192
    buffer_store_dwordx4 v[24:27], v2, s[20:23], s40 offen
    s_add_u32 s40, s39, 12288
    buffer_store_dwordx4 v[28:31], v2, s[20:23], s40 offen
    s_add_u32 s40, s39, 16384
    buffer_store_dwordx4 v[32:35], v2, s[20:23], s40 offen
    v_lshlrev_b32 v3, 3, v10
    v_cmp_eq_u32 vcc, 0, v12
    s_and_saveexec_b64 s[40:41], vcc
    s_mov_b32 s39, 131072
    buffer_store_dwordx2 v[6:7], v3, s[20:23], s39 offen
    s_mov_b64 exec, s[40:41]
    v_mov_b32 v2, 0
    s_waitcnt vmcnt(6)
    v_dot2_f32_bf16 v2, v16, v36, v2
    v_dot2_f32_bf16 v2, v17, v37, v2
    v_dot2_f32_bf16 v2, v18, v38, v2
    v_dot2_f32_bf16 v2, v19, v39, v2
    v_dot2_f32_bf16 v2, v20, v40, v2
    v_dot2_f32_bf16 v2, v21, v41, v2
    v_dot2_f32_bf16 v2, v22, v42, v2
    v_dot2_f32_bf16 v2, v23, v43, v2
    v_dot2_f32_bf16 v2, v24, v44, v2
    v_dot2_f32_bf16 v2, v25, v45, v2
    v_dot2_f32_bf16 v2, v26, v46, v2
    v_dot2_f32_bf16 v2, v27, v47, v2
    v_dot2_f32_bf16 v2, v28, v48, v2
    v_dot2_f32_bf16 v2, v29, v49, v2
    v_dot2_f32_bf16 v2, v30, v50, v2
    v_dot2_f32_bf16 v2, v31, v51, v2
    v_dot2_f32_bf16 v2, v32, v52, v2
    v_dot2_f32_bf16 v2, v33, v53, v2
    v_dot2_f32_bf16 v2, v34, v54, v2
    v_dot2_f32_bf16 v2, v35, v55, v2
    s_nop 3
    v_add_f32_dpp v2, v2, v2 row_ror:1 row_mask:0xf bank_mask:0xf
    s_nop 1
    v_add_f32_dpp v2, v2, v2 row_ror:2 row_mask:0xf bank_mask:0xf
    s_nop 1
    v_add_f32_dpp v2, v2, v2 row_ror:4 row_mask:0xf bank_mask:0xf
    s_nop 1
    v_add_f32_dpp v2, v2, v2 row_ror:8 row_mask:0xf bank_mask:0xf
    s_nop 1
    v_cvt_pk_bf16_f32 v2, v2, v2
    v_and_b32 v2, 0xffff0000, v2
    v_ashrrev_i32 v3, 31, v2
    v_or_b32 v3, 0x80000000, v3
    v_xor_b32 v2, v2, v3
    v_and_b32 v2, 0xffff0000, v2
    v_sub_u32 v3, 2047, v10
    v_or_b32 v2, v2, v3
    v_mov_b32 v3, v2
    s_nop 1
    v_permlane16_swap_b32 v2, v3
    s_nop 1
    v_max_u32 v2, v2, v3
    v_mov_b32 v3, v2
    s_nop 1
    v_permlane32_swap_b32 v2, v3
    s_nop 1
    v_max_u32 v2, v2, v3
    s_add_u32 s39, s38, 163840
    v_mov_b32 v3, 0
    s_mov_b64 exec, 1
    buffer_store_dword v2, v3, s[20:23], s39 offen
K0_END:
K0_END2:
    s_endpgm
.globl k1_kernel
.p2align 8
.type k1_kernel,@function
k1_kernel:

    s_cmp_ge_u32 s2, 256
    s_cbranch_scc1 K1_END
    s_load_dwordx2 s[52:53], s[0:1], 16
    s_load_dwordx4 s[24:27], s[0:1], 48
    s_load_dwordx2 s[28:29], s[0:1], 64
    s_load_dwordx4 s[60:63], s[0:1], 80
    v_and_b32 v1, 63, v0
    v_lshrrev_b32 v10, 6, v0
    s_nop 0
    v_readfirstlane_b32 s37, v10
    s_and_b32 s38, s2, 7
    s_lshr_b32 s39, s2, 3
    s_and_b32 s40, s38, 3
    s_lshl_b32 s40, s40, 2
    s_and_b32 s41, s39, 3
    s_add_u32 s32, s40, s41
    s_lshr_b32 s42, s38, 2
    s_lshr_b32 s41, s39, 2
    s_lshl_b32 s40, s42, 3
    s_add_u32 s33, s40, s41
    s_and_b32 s40, s39, 3
    s_mul_i32 s40, s40, 0
    s_mul_i32 s73, s41, 0
    s_add_u32 s73, s73, s40
    s_mul_i32 s40, s73, 13108
    s_lshr_b32 s40, s40, 16
    s_mul_i32 s40, s40, 5
    s_sub_u32 s73, s73, s40
    s_mov_b32 s44, 0x3fb8aa3b
    s_mov_b32 s45, 0x3fb8aa3b
    s_waitcnt lgkmcnt(0)
    s_mov_b32 s4, s52
    s_mov_b32 s5, s53
    s_mov_b32 s6, 25600
    s_mov_b32 s7, 0x20000
    s_mov_b32 s8, s62
    s_mov_b32 s9, s63
    s_mov_b32 s10, 268435456
    s_mov_b32 s11, 0x20000
    v_lshlrev_b32 v2, 4, v1
    s_lshl_b32 s38, s32, 3
    s_lshl_b32 s39, s37, 1
    s_add_u32 s38, s38, s39
    s_mul_i32 s46, s38, 20480
    s_add_u32 s46, s46, 8388608
    s_mul_i32 s47, s33, 153600
    s_add_u32 s47, s47, 12582912
    s_lshl_b32 s72, s37, 10
    s_mov_b32 s40, s73
    s_lshl_b32 s41, s40, 12
    s_add_u32 s48, s41, s46
    s_mul_i32 s41, s40, 30720
    s_add_u32 s41, s41, s47
    s_add_u32 s49, s41, s72
    s_add_u32 s40, s40, 1
    s_cmp_eq_u32 s40, 5
    s_cselect_b32 s40, 0, s40
    s_lshl_b32 s41, s40, 12
    s_add_u32 s50, s41, s46
    s_mul_i32 s41, s40, 30720
    s_add_u32 s41, s41, s47
    s_add_u32 s51, s41, s72
    s_add_u32 s40, s40, 1
    s_cmp_eq_u32 s40, 5
    s_cselect_b32 s40, 0, s40
    s_lshl_b32 s41, s40, 12
    s_add_u32 s52, s41, s46
    s_mul_i32 s41, s40, 30720
    s_add_u32 s41, s41, s47
    s_add_u32 s53, s41, s72
    s_add_u32 s40, s40, 1
    s_cmp_eq_u32 s40, 5
    s_cselect_b32 s40, 0, s40
    s_lshl_b32 s41, s40, 12
    s_add_u32 s54, s41, s46
    s_mul_i32 s41, s40, 30720
    s_add_u32 s41, s41, s47
    s_add_u32 s55, s41, s72
    s_add_u32 s40, s40, 1
    s_cmp_eq_u32 s40, 5
    s_cselect_b32 s40, 0, s40
    s_lshl_b32 s41, s40, 12
    s_add_u32 s56, s41, s46
    s_mul_i32 s41, s40, 30720
    s_add_u32 s41, s41, s47
    s_add_u32 s57, s41, s72
    s_add_u32 s40, s40, 1
    s_cmp_eq_u32 s40, 5
    s_cselect_b32 s40, 0, s40
    buffer_load_dwordx4 a[0:3], v2, s[8:11], s48 offen offset:0
    s_add_u32 s41, s48, 20480
    buffer_load_dwordx4 a[80:83], v2, s[8:11], s41 offen offset:0
    s_add_u32 m0, s72, 0
    s_add_u32 s41, s49, 0
    buffer_load_dwordx4 v2, s[8:11], s41 offen lds
    s_add_u32 m0, s72, 4096
    s_add_u32 s41, s49, 4096
    buffer_load_dwordx4 v2, s[8:11], s41 offen lds
    buffer_load_dwordx4 a[4:7], v2, s[8:11], s48 offen offset:1024
    s_add_u32 s41, s48, 20480
    buffer_load_dwordx4 a[84:87], v2, s[8:11], s41 offen offset:1024
    s_add_u32 m0, s72, 8192
    s_add_u32 s41, s49, 8192
    buffer_load_dwordx4 v2, s[8:11], s41 offen lds
    s_add_u32 m0, s72, 12288
    s_add_u32 s41, s49, 12288
    buffer_load_dwordx4 v2, s[8:11], s41 offen lds
    buffer_load_dwordx4 a[8:11], v2, s[8:11], s48 offen offset:2048
    s_add_u32 s41, s48, 20480
    buffer_load_dwordx4 a[88:91], v2, s[8:11], s41 offen offset:2048
    s_add_u32 m0, s72, 16384
    s_add_u32 s41, s49, 16384
    buffer_load_dwordx4 v2, s[8:11], s41 offen lds
    s_add_u32 m0, s72, 20480
    s_add_u32 s41, s49, 20480
    buffer_load_dwordx4 v2, s[8:11], s41 offen lds
    buffer_load_dwordx4 a[12:15], v2, s[8:11], s48 offen offset:3072
    s_add_u32 s41, s48, 20480
    buffer_load_dwordx4 a[92:95], v2, s[8:11], s41 offen offset:3072
    s_add_u32 m0, s72, 24576
    s_add_u32 s41, s49, 24576
    buffer_load_dwordx4 v2, s[8:11], s41 offen lds
    s_cmp_ge_u32 s37, 2
    s_cbranch_scc1 K1_SKIPC0
    s_add_u32 m0, s72, 28672
    s_add_u32 s41, s49, 28672
    buffer_load_dwordx4 v2, s[8:11], s41 offen lds
K1_SKIPC0:
    s_barrier
    buffer_load_dwordx4 a[16:19], v2, s[8:11], s50 offen offset:0
    s_add_u32 s41, s50, 20480
    buffer_load_dwordx4 a[96:99], v2, s[8:11], s41 offen offset:0
    s_add_u32 m0, s72, 30720
    s_add_u32 s41, s51, 0
    buffer_load_dwordx4 v2, s[8:11], s41 offen lds
    s_add_u32 m0, s72, 34816
    s_add_u32 s41, s51, 4096
    buffer_load_dwordx4 v2, s[8:11], s41 offen lds
    buffer_load_dwordx4 a[20:23], v2, s[8:11], s50 offen offset:1024
    s_add_u32 s41, s50, 20480
    buffer_load_dwordx4 a[100:103], v2, s[8:11], s41 offen offset:1024
    s_add_u32 m0, s72, 38912
    s_add_u32 s41, s51, 8192
    buffer_load_dwordx4 v2, s[8:11], s41 offen lds
    s_add_u32 m0, s72, 43008
    s_add_u32 s41, s51, 12288
    buffer_load_dwordx4 v2, s[8:11], s41 offen lds
    s_cmp_ge_u32 s37, 2
    s_cbranch_scc1 K1_MISC_Z
    s_mul_i32 s38, s33, 1600
    v_lshlrev_b32 v10, 4, v0
    s_add_u32 m0, s72, 155648
    v_cmp_gt_u32 vcc, 100, v0
    s_and_saveexec_b64 s[64:65], vcc
    buffer_load_dwordx4 v10, s[4:7], s38 offen lds
    s_mov_b64 exec, s[64:65]
    s_branch K1_MISC_DONE
K1_MISC_Z:
    s_cmp_lg_u32 s37, 2
    s_cbranch_scc1 K1_MISC_DONE
    v_mov_b32 v10, 0
    v_mov_b32 v11, 0
    v_mov_b32 v12, 0
    v_mov_b32 v13, 0
    v_add_u32 v14, 157248, v2
    v_cmp_gt_u32 vcc, 56, v1
    s_and_saveexec_b64 s[64:65], vcc
    ds_write_b128 v14, v[10:13]
    s_mov_b64 exec, s[64:65]
K1_MISC_DONE:
    v_lshrrev_b32 v3, 4, v1
    v_lshlrev_b32 v3, 3, v3
    v_bfe_u32 v4, v1, 3, 1
    v_lshlrev_b32 v4, 2, v4
    v_and_b32 v5, 3, v1
    v_add3_u32 v3, v3, v4, v5
    v_lshlrev_b32 v3, 4, v3
    v_add_u32 v3, 7168, v3
    s_waitcnt vmcnt(8) lgkmcnt(0)
    s_barrier
    v_add_u32 v14, 0, v2
    v_add_u32 v15, 0, v3
    ds_read_b128 v[80:83], v14
    ds_read_b128 v[84:87], v14 offset:1024
    ds_read_b128 v[88:91], v14 offset:2048
    ds_read_b128 v[92:95], v14 offset:3072
    ds_read_b128 v[96:99], v14 offset:4096
    ds_read_b128 v[100:103], v14 offset:5120
    ds_read_b128 v[104:107], v14 offset:6144
    ds_read_b128 v[108:111], v15
    buffer_load_dwordx4 a[24:27], v2, s[8:11], s50 offen offset:2048
    s_add_u32 s41, s50, 20480
    buffer_load_dwordx4 a[104:107], v2, s[8:11], s41 offen offset:2048
    s_add_u32 m0, s72, 47104
    s_add_u32 s41, s51, 16384
    buffer_load_dwordx4 v2, s[8:11], s41 offen lds
    s_add_u32 m0, s72, 51200
    s_add_u32 s41, s51, 20480
    buffer_load_dwordx4 v2, s[8:11], s41 offen lds
    s_waitcnt lgkmcnt(0)
    v_mfma_f32_16x16x32_bf16 v[16:19], v[80:83], a[0:3], 0
    v_mfma_f32_16x16x32_bf16 v[48:51], v[80:83], a[80:83], 0
    v_add_u32 v14, 7680, v2
    v_add_u32 v15, 7680, v3
    ds_read_b128 v[112:115], v14
    ds_read_b128 v[116:119], v14 offset:1024
    v_mfma_f32_16x16x32_bf16 v[20:23], v[84:87], a[0:3], 0
    v_mfma_f32_16x16x32_bf16 v[52:55], v[84:87], a[80:83], 0
    ds_read_b128 v[120:123], v14 offset:2048
    ds_read_b128 v[124:127], v14 offset:3072
    v_mfma_f32_16x16x32_bf16 v[24:27], v[88:91], a[0:3], 0
    v_mfma_f32_16x16x32_bf16 v[56:59], v[88:91], a[80:83], 0
    ds_read_b128 v[128:131], v14 offset:4096
    ds_read_b128 v[132:135], v14 offset:5120
    v_mfma_f32_16x16x32_bf16 v[28:31], v[92:95], a[0:3], 0
    v_mfma_f32_16x16x32_bf16 v[60:63], v[92:95], a[80:83], 0
    ds_read_b128 v[136:139], v14 offset:6144
    ds_read_b128 v[140:143], v15
    v_mfma_f32_16x16x32_bf16 v[32:35], v[96:99], a[0:3], 0
    v_mfma_f32_16x16x32_bf16 v[64:67], v[96:99], a[80:83], 0
    v_mfma_f32_16x16x32_bf16 v[36:39], v[100:103], a[0:3], 0
    v_mfma_f32_16x16x32_bf16 v[68:71], v[100:103], a[80:83], 0
    v_mfma_f32_16x16x32_bf16 v[40:43], v[104:107], a[0:3], 0
    v_mfma_f32_16x16x32_bf16 v[72:75], v[104:107], a[80:83], 0
    v_mfma_f32_16x16x32_bf16 v[44:47], v[108:111], a[0:3], 0
    v_mfma_f32_16x16x32_bf16 v[76:79], v[108:111], a[80:83], 0
    buffer_load_dwordx4 a[28:31], v2, s[8:11], s50 offen offset:3072
    s_add_u32 s41, s50, 20480
    buffer_load_dwordx4 a[108:111], v2, s[8:11], s41 offen offset:3072
    s_add_u32 m0, s72, 55296
    s_add_u32 s41, s51, 24576
    buffer_load_dwordx4 v2, s[8:11], s41 offen lds
    s_cmp_ge_u32 s37, 2
    s_cbranch_scc1 K1_SKIPC1
    s_add_u32 m0, s72, 59392
    s_add_u32 s41, s51, 28672
    buffer_load_dwordx4 v2, s[8:11], s41 offen lds
K1_SKIPC1:
    s_waitcnt lgkmcnt(0)
    v_mfma_f32_16x16x32_bf16 v[16:19], v[112:115], a[4:7], v[16:19]
    v_mfma_f32_16x16x32_bf16 v[48:51], v[112:115], a[84:87], v[48:51]
    v_add_u32 v14, 15360, v2
    v_add_u32 v15, 15360, v3
    ds_read_b128 v[80:83], v14
    ds_read_b128 v[84:87], v14 offset:1024
    v_mfma_f32_16x16x32_bf16 v[20:23], v[116:119], a[4:7], v[20:23]
    v_mfma_f32_16x16x32_bf16 v[52:55], v[116:119], a[84:87], v[52:55]
    ds_read_b128 v[88:91], v14 offset:2048
    ds_read_b128 v[92:95], v14 offset:3072
    v_mfma_f32_16x16x32_bf16 v[24:27], v[120:123], a[4:7], v[24:27]
    v_mfma_f32_16x16x32_bf16 v[56:59], v[120:123], a[84:87], v[56:59]
    ds_read_b128 v[96:99], v14 offset:4096
    ds_read_b128 v[100:103], v14 offset:5120
    v_mfma_f32_16x16x32_bf16 v[28:31], v[124:127], a[4:7], v[28:31]
    v_mfma_f32_16x16x32_bf16 v[60:63], v[124:127], a[84:87], v[60:63]
    ds_read_b128 v[104:107], v14 offset:6144
    ds_read_b128 v[108:111], v15
    v_mfma_f32_16x16x32_bf16 v[32:35], v[128:131], a[4:7], v[32:35]
    v_mfma_f32_16x16x32_bf16 v[64:67], v[128:131], a[84:87], v[64:67]
    v_mfma_f32_16x16x32_bf16 v[36:39], v[132:135], a[4:7], v[36:39]
    v_mfma_f32_16x16x32_bf16 v[68:71], v[132:135], a[84:87], v[68:71]
    v_mfma_f32_16x16x32_bf16 v[40:43], v[136:139], a[4:7], v[40:43]
    v_mfma_f32_16x16x32_bf16 v[72:75], v[136:139], a[84:87], v[72:75]
    v_mfma_f32_16x16x32_bf16 v[44:47], v[140:143], a[4:7], v[44:47]
    v_mfma_f32_16x16x32_bf16 v[76:79], v[140:143], a[84:87], v[76:79]
    buffer_load_dwordx4 a[32:35], v2, s[8:11], s52 offen offset:0
    s_add_u32 s41, s52, 20480
    buffer_load_dwordx4 a[112:115], v2, s[8:11], s41 offen offset:0
    s_add_u32 m0, s72, 61440
    s_add_u32 s41, s53, 0
    buffer_load_dwordx4 v2, s[8:11], s41 offen lds
    s_add_u32 m0, s72, 65536
    s_add_u32 s41, s53, 4096
    buffer_load_dwordx4 v2, s[8:11], s41 offen lds
    s_waitcnt lgkmcnt(0)
    v_mfma_f32_16x16x32_bf16 v[16:19], v[80:83], a[8:11], v[16:19]
    v_mfma_f32_16x16x32_bf16 v[48:51], v[80:83], a[88:91], v[48:51]
    v_add_u32 v14, 23040, v2
    v_add_u32 v15, 23040, v3
    ds_read_b128 v[112:115], v14
    ds_read_b128 v[116:119], v14 offset:1024
    v_mfma_f32_16x16x32_bf16 v[20:23], v[84:87], a[8:11], v[20:23]
    v_mfma_f32_16x16x32_bf16 v[52:55], v[84:87], a[88:91], v[52:55]
    ds_read_b128 v[120:123], v14 offset:2048
    ds_read_b128 v[124:127], v14 offset:3072
    v_mfma_f32_16x16x32_bf16 v[24:27], v[88:91], a[8:11], v[24:27]
    v_mfma_f32_16x16x32_bf16 v[56:59], v[88:91], a[88:91], v[56:59]
    ds_read_b128 v[128:131], v14 offset:4096
    ds_read_b128 v[132:135], v14 offset:5120
    v_mfma_f32_16x16x32_bf16 v[28:31], v[92:95], a[8:11], v[28:31]
    v_mfma_f32_16x16x32_bf16 v[60:63], v[92:95], a[88:91], v[60:63]
    ds_read_b128 v[136:139], v14 offset:6144
    ds_read_b128 v[140:143], v15
    v_mfma_f32_16x16x32_bf16 v[32:35], v[96:99], a[8:11], v[32:35]
    v_mfma_f32_16x16x32_bf16 v[64:67], v[96:99], a[88:91], v[64:67]
    v_mfma_f32_16x16x32_bf16 v[36:39], v[100:103], a[8:11], v[36:39]
    v_mfma_f32_16x16x32_bf16 v[68:71], v[100:103], a[88:91], v[68:71]
    v_mfma_f32_16x16x32_bf16 v[40:43], v[104:107], a[8:11], v[40:43]
    v_mfma_f32_16x16x32_bf16 v[72:75], v[104:107], a[88:91], v[72:75]
    v_mfma_f32_16x16x32_bf16 v[44:47], v[108:111], a[8:11], v[44:47]
    v_mfma_f32_16x16x32_bf16 v[76:79], v[108:111], a[88:91], v[76:79]
    buffer_load_dwordx4 a[36:39], v2, s[8:11], s52 offen offset:1024
    s_add_u32 s41, s52, 20480
    buffer_load_dwordx4 a[116:119], v2, s[8:11], s41 offen offset:1024
    s_add_u32 m0, s72, 69632
    s_add_u32 s41, s53, 8192
    buffer_load_dwordx4 v2, s[8:11], s41 offen lds
    s_add_u32 m0, s72, 73728
    s_add_u32 s41, s53, 12288
    buffer_load_dwordx4 v2, s[8:11], s41 offen lds
    s_waitcnt lgkmcnt(0)
    v_mfma_f32_16x16x32_bf16 v[16:19], v[112:115], a[12:15], v[16:19]
    v_mfma_f32_16x16x32_bf16 v[48:51], v[112:115], a[92:95], v[48:51]
    v_mfma_f32_16x16x32_bf16 v[20:23], v[116:119], a[12:15], v[20:23]
    v_mfma_f32_16x16x32_bf16 v[52:55], v[116:119], a[92:95], v[52:55]
    v_mfma_f32_16x16x32_bf16 v[24:27], v[120:123], a[12:15], v[24:27]
    v_mfma_f32_16x16x32_bf16 v[56:59], v[120:123], a[92:95], v[56:59]
    v_mfma_f32_16x16x32_bf16 v[28:31], v[124:127], a[12:15], v[28:31]
    v_mfma_f32_16x16x32_bf16 v[60:63], v[124:127], a[92:95], v[60:63]
    v_mfma_f32_16x16x32_bf16 v[32:35], v[128:131], a[12:15], v[32:35]
    v_mfma_f32_16x16x32_bf16 v[64:67], v[128:131], a[92:95], v[64:67]
    v_mfma_f32_16x16x32_bf16 v[36:39], v[132:135], a[12:15], v[36:39]
    v_mfma_f32_16x16x32_bf16 v[68:71], v[132:135], a[92:95], v[68:71]
    v_mfma_f32_16x16x32_bf16 v[40:43], v[136:139], a[12:15], v[40:43]
    v_mfma_f32_16x16x32_bf16 v[72:75], v[136:139], a[92:95], v[72:75]
    v_mfma_f32_16x16x32_bf16 v[44:47], v[140:143], a[12:15], v[44:47]
    v_mfma_f32_16x16x32_bf16 v[76:79], v[140:143], a[92:95], v[76:79]
    s_waitcnt vmcnt(8) lgkmcnt(0)
    s_barrier
    v_add_u32 v14, 30720, v2
    v_add_u32 v15, 30720, v3
    ds_read_b128 v[80:83], v14
    ds_read_b128 v[84:87], v14 offset:1024
    ds_read_b128 v[88:91], v14 offset:2048
    ds_read_b128 v[92:95], v14 offset:3072
    ds_read_b128 v[96:99], v14 offset:4096
    ds_read_b128 v[100:103], v14 offset:5120
    ds_read_b128 v[104:107], v14 offset:6144
    ds_read_b128 v[108:111], v15
    buffer_load_dwordx4 a[40:43], v2, s[8:11], s52 offen offset:2048
    s_add_u32 s41, s52, 20480
    buffer_load_dwordx4 a[120:123], v2, s[8:11], s41 offen offset:2048
    s_add_u32 m0, s72, 77824
    s_add_u32 s41, s53, 16384
    buffer_load_dwordx4 v2, s[8:11], s41 offen lds
    s_add_u32 m0, s72, 81920
    s_add_u32 s41, s53, 20480
    buffer_load_dwordx4 v2, s[8:11], s41 offen lds
    s_waitcnt lgkmcnt(0)
    v_mfma_f32_16x16x32_bf16 v[16:19], v[80:83], a[16:19], v[16:19]
    v_mfma_f32_16x16x32_bf16 v[48:51], v[80:83], a[96:99], v[48:51]
    v_add_u32 v14, 38400, v2
    v_add_u32 v15, 38400, v3
    ds_read_b128 v[112:115], v14
    ds_read_b128 v[116:119], v14 offset:1024
    v_mfma_f32_16x16x32_bf16 v[20:23], v[84:87], a[16:19], v[20:23]
    v_mfma_f32_16x16x32_bf16 v[52:55], v[84:87], a[96:99], v[52:55]
    ds_read_b128 v[120:123], v14 offset:2048
    ds_read_b128 v[124:127], v14 offset:3072
    v_mfma_f32_16x16x32_bf16 v[24:27], v[88:91], a[16:19], v[24:27]
    v_mfma_f32_16x16x32_bf16 v[56:59], v[88:91], a[96:99], v[56:59]
    ds_read_b128 v[128:131], v14 offset:4096
    ds_read_b128 v[132:135], v14 offset:5120
    v_mfma_f32_16x16x32_bf16 v[28:31], v[92:95], a[16:19], v[28:31]
    v_mfma_f32_16x16x32_bf16 v[60:63], v[92:95], a[96:99], v[60:63]
    ds_read_b128 v[136:139], v14 offset:6144
    ds_read_b128 v[140:143], v15
    v_mfma_f32_16x16x32_bf16 v[32:35], v[96:99], a[16:19], v[32:35]
    v_mfma_f32_16x16x32_bf16 v[64:67], v[96:99], a[96:99], v[64:67]
    v_mfma_f32_16x16x32_bf16 v[36:39], v[100:103], a[16:19], v[36:39]
    v_mfma_f32_16x16x32_bf16 v[68:71], v[100:103], a[96:99], v[68:71]
    v_mfma_f32_16x16x32_bf16 v[40:43], v[104:107], a[16:19], v[40:43]
    v_mfma_f32_16x16x32_bf16 v[72:75], v[104:107], a[96:99], v[72:75]
    v_mfma_f32_16x16x32_bf16 v[44:47], v[108:111], a[16:19], v[44:47]
    v_mfma_f32_16x16x32_bf16 v[76:79], v[108:111], a[96:99], v[76:79]
    buffer_load_dwordx4 a[44:47], v2, s[8:11], s52 offen offset:3072
    s_add_u32 s41, s52, 20480
    buffer_load_dwordx4 a[124:127], v2, s[8:11], s41 offen offset:3072
    s_add_u32 m0, s72, 86016
    s_add_u32 s41, s53, 24576
    buffer_load_dwordx4 v2, s[8:11], s41 offen lds
    s_cmp_ge_u32 s37, 2
    s_cbranch_scc1 K1_SKIPC2
    s_add_u32 m0, s72, 90112
    s_add_u32 s41, s53, 28672
    buffer_load_dwordx4 v2, s[8:11], s41 offen lds
K1_SKIPC2:
    s_waitcnt lgkmcnt(0)
    v_mfma_f32_16x16x32_bf16 v[16:19], v[112:115], a[20:23], v[16:19]
    v_mfma_f32_16x16x32_bf16 v[48:51], v[112:115], a[100:103], v[48:51]
    v_add_u32 v14, 46080, v2
    v_add_u32 v15, 46080, v3
    ds_read_b128 v[80:83], v14
    ds_read_b128 v[84:87], v14 offset:1024
    v_mfma_f32_16x16x32_bf16 v[20:23], v[116:119], a[20:23], v[20:23]
    v_mfma_f32_16x16x32_bf16 v[52:55], v[116:119], a[100:103], v[52:55]
    ds_read_b128 v[88:91], v14 offset:2048
    ds_read_b128 v[92:95], v14 offset:3072
    v_mfma_f32_16x16x32_bf16 v[24:27], v[120:123], a[20:23], v[24:27]
    v_mfma_f32_16x16x32_bf16 v[56:59], v[120:123], a[100:103], v[56:59]
    ds_read_b128 v[96:99], v14 offset:4096
    ds_read_b128 v[100:103], v14 offset:5120
    v_mfma_f32_16x16x32_bf16 v[28:31], v[124:127], a[20:23], v[28:31]
    v_mfma_f32_16x16x32_bf16 v[60:63], v[124:127], a[100:103], v[60:63]
    ds_read_b128 v[104:107], v14 offset:6144
    ds_read_b128 v[108:111], v15
    v_mfma_f32_16x16x32_bf16 v[32:35], v[128:131], a[20:23], v[32:35]
    v_mfma_f32_16x16x32_bf16 v[64:67], v[128:131], a[100:103], v[64:67]
    v_mfma_f32_16x16x32_bf16 v[36:39], v[132:135], a[20:23], v[36:39]
    v_mfma_f32_16x16x32_bf16 v[68:71], v[132:135], a[100:103], v[68:71]
    v_mfma_f32_16x16x32_bf16 v[40:43], v[136:139], a[20:23], v[40:43]
    v_mfma_f32_16x16x32_bf16 v[72:75], v[136:139], a[100:103], v[72:75]
    v_mfma_f32_16x16x32_bf16 v[44:47], v[140:143], a[20:23], v[44:47]
    v_mfma_f32_16x16x32_bf16 v[76:79], v[140:143], a[100:103], v[76:79]
    buffer_load_dwordx4 a[48:51], v2, s[8:11], s54 offen offset:0
    s_add_u32 s41, s54, 20480
    buffer_load_dwordx4 a[128:131], v2, s[8:11], s41 offen offset:0
    s_add_u32 m0, s72, 92160
    s_add_u32 s41, s55, 0
    buffer_load_dwordx4 v2, s[8:11], s41 offen lds
    s_add_u32 m0, s72, 96256
    s_add_u32 s41, s55, 4096
    buffer_load_dwordx4 v2, s[8:11], s41 offen lds
    s_waitcnt lgkmcnt(0)
    v_mfma_f32_16x16x32_bf16 v[16:19], v[80:83], a[24:27], v[16:19]
    v_mfma_f32_16x16x32_bf16 v[48:51], v[80:83], a[104:107], v[48:51]
    v_add_u32 v14, 53760, v2
    v_add_u32 v15, 53760, v3
    ds_read_b128 v[112:115], v14
    ds_read_b128 v[116:119], v14 offset:1024
    v_mfma_f32_16x16x32_bf16 v[20:23], v[84:87], a[24:27], v[20:23]
    v_mfma_f32_16x16x32_bf16 v[52:55], v[84:87], a[104:107], v[52:55]
    ds_read_b128 v[120:123], v14 offset:2048
    ds_read_b128 v[124:127], v14 offset:3072
    v_mfma_f32_16x16x32_bf16 v[24:27], v[88:91], a[24:27], v[24:27]
    v_mfma_f32_16x16x32_bf16 v[56:59], v[88:91], a[104:107], v[56:59]
    ds_read_b128 v[128:131], v14 offset:4096
    ds_read_b128 v[132:135], v14 offset:5120
    v_mfma_f32_16x16x32_bf16 v[28:31], v[92:95], a[24:27], v[28:31]
    v_mfma_f32_16x16x32_bf16 v[60:63], v[92:95], a[104:107], v[60:63]
    ds_read_b128 v[136:139], v14 offset:6144
    ds_read_b128 v[140:143], v15
    v_mfma_f32_16x16x32_bf16 v[32:35], v[96:99], a[24:27], v[32:35]
    v_mfma_f32_16x16x32_bf16 v[64:67], v[96:99], a[104:107], v[64:67]
    v_mfma_f32_16x16x32_bf16 v[36:39], v[100:103], a[24:27], v[36:39]
    v_mfma_f32_16x16x32_bf16 v[68:71], v[100:103], a[104:107], v[68:71]
    v_mfma_f32_16x16x32_bf16 v[40:43], v[104:107], a[24:27], v[40:43]
    v_mfma_f32_16x16x32_bf16 v[72:75], v[104:107], a[104:107], v[72:75]
    v_mfma_f32_16x16x32_bf16 v[44:47], v[108:111], a[24:27], v[44:47]
    v_mfma_f32_16x16x32_bf16 v[76:79], v[108:111], a[104:107], v[76:79]
    buffer_load_dwordx4 a[52:55], v2, s[8:11], s54 offen offset:1024
    s_add_u32 s41, s54, 20480
    buffer_load_dwordx4 a[132:135], v2, s[8:11], s41 offen offset:1024
    s_add_u32 m0, s72, 100352
    s_add_u32 s41, s55, 8192
    buffer_load_dwordx4 v2, s[8:11], s41 offen lds
    s_add_u32 m0, s72, 104448
    s_add_u32 s41, s55, 12288
    buffer_load_dwordx4 v2, s[8:11], s41 offen lds
    s_waitcnt lgkmcnt(0)
    v_mfma_f32_16x16x32_bf16 v[16:19], v[112:115], a[28:31], v[16:19]
    v_mfma_f32_16x16x32_bf16 v[48:51], v[112:115], a[108:111], v[48:51]
    v_mfma_f32_16x16x32_bf16 v[20:23], v[116:119], a[28:31], v[20:23]
    v_mfma_f32_16x16x32_bf16 v[52:55], v[116:119], a[108:111], v[52:55]
    v_mfma_f32_16x16x32_bf16 v[24:27], v[120:123], a[28:31], v[24:27]
    v_mfma_f32_16x16x32_bf16 v[56:59], v[120:123], a[108:111], v[56:59]
    v_mfma_f32_16x16x32_bf16 v[28:31], v[124:127], a[28:31], v[28:31]
    v_mfma_f32_16x16x32_bf16 v[60:63], v[124:127], a[108:111], v[60:63]
    v_mfma_f32_16x16x32_bf16 v[32:35], v[128:131], a[28:31], v[32:35]
    v_mfma_f32_16x16x32_bf16 v[64:67], v[128:131], a[108:111], v[64:67]
    v_mfma_f32_16x16x32_bf16 v[36:39], v[132:135], a[28:31], v[36:39]
    v_mfma_f32_16x16x32_bf16 v[68:71], v[132:135], a[108:111], v[68:71]
    v_mfma_f32_16x16x32_bf16 v[40:43], v[136:139], a[28:31], v[40:43]
    v_mfma_f32_16x16x32_bf16 v[72:75], v[136:139], a[108:111], v[72:75]
    v_mfma_f32_16x16x32_bf16 v[44:47], v[140:143], a[28:31], v[44:47]
    v_mfma_f32_16x16x32_bf16 v[76:79], v[140:143], a[108:111], v[76:79]
    s_waitcnt vmcnt(8) lgkmcnt(0)
    s_barrier
    v_add_u32 v14, 61440, v2
    v_add_u32 v15, 61440, v3
    ds_read_b128 v[80:83], v14
    ds_read_b128 v[84:87], v14 offset:1024
    ds_read_b128 v[88:91], v14 offset:2048
    ds_read_b128 v[92:95], v14 offset:3072
    ds_read_b128 v[96:99], v14 offset:4096
    ds_read_b128 v[100:103], v14 offset:5120
    ds_read_b128 v[104:107], v14 offset:6144
    ds_read_b128 v[108:111], v15
    buffer_load_dwordx4 a[56:59], v2, s[8:11], s54 offen offset:2048
    s_add_u32 s41, s54, 20480
    buffer_load_dwordx4 a[136:139], v2, s[8:11], s41 offen offset:2048
    s_add_u32 m0, s72, 108544
    s_add_u32 s41, s55, 16384
    buffer_load_dwordx4 v2, s[8:11], s41 offen lds
    s_add_u32 m0, s72, 112640
    s_add_u32 s41, s55, 20480
    buffer_load_dwordx4 v2, s[8:11], s41 offen lds
    s_waitcnt lgkmcnt(0)
    v_mfma_f32_16x16x32_bf16 v[16:19], v[80:83], a[32:35], v[16:19]
    v_mfma_f32_16x16x32_bf16 v[48:51], v[80:83], a[112:115], v[48:51]
    v_add_u32 v14, 69120, v2
    v_add_u32 v15, 69120, v3
    ds_read_b128 v[112:115], v14
    ds_read_b128 v[116:119], v14 offset:1024
    v_mfma_f32_16x16x32_bf16 v[20:23], v[84:87], a[32:35], v[20:23]
    v_mfma_f32_16x16x32_bf16 v[52:55], v[84:87], a[112:115], v[52:55]
    ds_read_b128 v[120:123], v14 offset:2048
    ds_read_b128 v[124:127], v14 offset:3072
    v_mfma_f32_16x16x32_bf16 v[24:27], v[88:91], a[32:35], v[24:27]
    v_mfma_f32_16x16x32_bf16 v[56:59], v[88:91], a[112:115], v[56:59]
    ds_read_b128 v[128:131], v14 offset:4096
    ds_read_b128 v[132:135], v14 offset:5120
    v_mfma_f32_16x16x32_bf16 v[28:31], v[92:95], a[32:35], v[28:31]
    v_mfma_f32_16x16x32_bf16 v[60:63], v[92:95], a[112:115], v[60:63]
    ds_read_b128 v[136:139], v14 offset:6144
    ds_read_b128 v[140:143], v15
    v_mfma_f32_16x16x32_bf16 v[32:35], v[96:99], a[32:35], v[32:35]
    v_mfma_f32_16x16x32_bf16 v[64:67], v[96:99], a[112:115], v[64:67]
    v_mfma_f32_16x16x32_bf16 v[36:39], v[100:103], a[32:35], v[36:39]
    v_mfma_f32_16x16x32_bf16 v[68:71], v[100:103], a[112:115], v[68:71]
    v_mfma_f32_16x16x32_bf16 v[40:43], v[104:107], a[32:35], v[40:43]
    v_mfma_f32_16x16x32_bf16 v[72:75], v[104:107], a[112:115], v[72:75]
    v_mfma_f32_16x16x32_bf16 v[44:47], v[108:111], a[32:35], v[44:47]
    v_mfma_f32_16x16x32_bf16 v[76:79], v[108:111], a[112:115], v[76:79]
    buffer_load_dwordx4 a[60:63], v2, s[8:11], s54 offen offset:3072
    s_add_u32 s41, s54, 20480
    buffer_load_dwordx4 a[140:143], v2, s[8:11], s41 offen offset:3072
    s_add_u32 m0, s72, 116736
    s_add_u32 s41, s55, 24576
    buffer_load_dwordx4 v2, s[8:11], s41 offen lds
    s_cmp_ge_u32 s37, 2
    s_cbranch_scc1 K1_SKIPC3
    s_add_u32 m0, s72, 120832
    s_add_u32 s41, s55, 28672
    buffer_load_dwordx4 v2, s[8:11], s41 offen lds
K1_SKIPC3:
    s_waitcnt lgkmcnt(0)
    v_mfma_f32_16x16x32_bf16 v[16:19], v[112:115], a[36:39], v[16:19]
    v_mfma_f32_16x16x32_bf16 v[48:51], v[112:115], a[116:119], v[48:51]
    v_add_u32 v14, 76800, v2
    v_add_u32 v15, 76800, v3
    ds_read_b128 v[80:83], v14
    ds_read_b128 v[84:87], v14 offset:1024
    v_mfma_f32_16x16x32_bf16 v[20:23], v[116:119], a[36:39], v[20:23]
    v_mfma_f32_16x16x32_bf16 v[52:55], v[116:119], a[116:119], v[52:55]
    ds_read_b128 v[88:91], v14 offset:2048
    ds_read_b128 v[92:95], v14 offset:3072
    v_mfma_f32_16x16x32_bf16 v[24:27], v[120:123], a[36:39], v[24:27]
    v_mfma_f32_16x16x32_bf16 v[56:59], v[120:123], a[116:119], v[56:59]
    ds_read_b128 v[96:99], v14 offset:4096
    ds_read_b128 v[100:103], v14 offset:5120
    v_mfma_f32_16x16x32_bf16 v[28:31], v[124:127], a[36:39], v[28:31]
    v_mfma_f32_16x16x32_bf16 v[60:63], v[124:127], a[116:119], v[60:63]
    ds_read_b128 v[104:107], v14 offset:6144
    ds_read_b128 v[108:111], v15
    v_mfma_f32_16x16x32_bf16 v[32:35], v[128:131], a[36:39], v[32:35]
    v_mfma_f32_16x16x32_bf16 v[64:67], v[128:131], a[116:119], v[64:67]
    v_mfma_f32_16x16x32_bf16 v[36:39], v[132:135], a[36:39], v[36:39]
    v_mfma_f32_16x16x32_bf16 v[68:71], v[132:135], a[116:119], v[68:71]
    v_mfma_f32_16x16x32_bf16 v[40:43], v[136:139], a[36:39], v[40:43]
    v_mfma_f32_16x16x32_bf16 v[72:75], v[136:139], a[116:119], v[72:75]
    v_mfma_f32_16x16x32_bf16 v[44:47], v[140:143], a[36:39], v[44:47]
    v_mfma_f32_16x16x32_bf16 v[76:79], v[140:143], a[116:119], v[76:79]
    buffer_load_dwordx4 a[64:67], v2, s[8:11], s56 offen offset:0
    s_add_u32 s41, s56, 20480
    buffer_load_dwordx4 a[144:147], v2, s[8:11], s41 offen offset:0
    s_add_u32 m0, s72, 122880
    s_add_u32 s41, s57, 0
    buffer_load_dwordx4 v2, s[8:11], s41 offen lds
    s_add_u32 m0, s72, 126976
    s_add_u32 s41, s57, 4096
    buffer_load_dwordx4 v2, s[8:11], s41 offen lds
    s_waitcnt lgkmcnt(0)
    v_mfma_f32_16x16x32_bf16 v[16:19], v[80:83], a[40:43], v[16:19]
    v_mfma_f32_16x16x32_bf16 v[48:51], v[80:83], a[120:123], v[48:51]
    v_add_u32 v14, 84480, v2
    v_add_u32 v15, 84480, v3
    ds_read_b128 v[112:115], v14
    ds_read_b128 v[116:119], v14 offset:1024
    v_mfma_f32_16x16x32_bf16 v[20:23], v[84:87], a[40:43], v[20:23]
    v_mfma_f32_16x16x32_bf16 v[52:55], v[84:87], a[120:123], v[52:55]
    ds_read_b128 v[120:123], v14 offset:2048
    ds_read_b128 v[124:127], v14 offset:3072
    v_mfma_f32_16x16x32_bf16 v[24:27], v[88:91], a[40:43], v[24:27]
    v_mfma_f32_16x16x32_bf16 v[56:59], v[88:91], a[120:123], v[56:59]
    ds_read_b128 v[128:131], v14 offset:4096
    ds_read_b128 v[132:135], v14 offset:5120
    v_mfma_f32_16x16x32_bf16 v[28:31], v[92:95], a[40:43], v[28:31]
    v_mfma_f32_16x16x32_bf16 v[60:63], v[92:95], a[120:123], v[60:63]
    ds_read_b128 v[136:139], v14 offset:6144
    ds_read_b128 v[140:143], v15
    v_mfma_f32_16x16x32_bf16 v[32:35], v[96:99], a[40:43], v[32:35]
    v_mfma_f32_16x16x32_bf16 v[64:67], v[96:99], a[120:123], v[64:67]
    v_mfma_f32_16x16x32_bf16 v[36:39], v[100:103], a[40:43], v[36:39]
    v_mfma_f32_16x16x32_bf16 v[68:71], v[100:103], a[120:123], v[68:71]
    v_mfma_f32_16x16x32_bf16 v[40:43], v[104:107], a[40:43], v[40:43]
    v_mfma_f32_16x16x32_bf16 v[72:75], v[104:107], a[120:123], v[72:75]
    v_mfma_f32_16x16x32_bf16 v[44:47], v[108:111], a[40:43], v[44:47]
    v_mfma_f32_16x16x32_bf16 v[76:79], v[108:111], a[120:123], v[76:79]
    buffer_load_dwordx4 a[68:71], v2, s[8:11], s56 offen offset:1024
    s_add_u32 s41, s56, 20480
    buffer_load_dwordx4 a[148:151], v2, s[8:11], s41 offen offset:1024
    s_add_u32 m0, s72, 131072
    s_add_u32 s41, s57, 8192
    buffer_load_dwordx4 v2, s[8:11], s41 offen lds
    s_add_u32 m0, s72, 135168
    s_add_u32 s41, s57, 12288
    buffer_load_dwordx4 v2, s[8:11], s41 offen lds
    s_waitcnt lgkmcnt(0)
    v_mfma_f32_16x16x32_bf16 v[16:19], v[112:115], a[44:47], v[16:19]
    v_mfma_f32_16x16x32_bf16 v[48:51], v[112:115], a[124:127], v[48:51]
    v_mfma_f32_16x16x32_bf16 v[20:23], v[116:119], a[44:47], v[20:23]
    v_mfma_f32_16x16x32_bf16 v[52:55], v[116:119], a[124:127], v[52:55]
    v_mfma_f32_16x16x32_bf16 v[24:27], v[120:123], a[44:47], v[24:27]
    v_mfma_f32_16x16x32_bf16 v[56:59], v[120:123], a[124:127], v[56:59]
    v_mfma_f32_16x16x32_bf16 v[28:31], v[124:127], a[44:47], v[28:31]
    v_mfma_f32_16x16x32_bf16 v[60:63], v[124:127], a[124:127], v[60:63]
    v_mfma_f32_16x16x32_bf16 v[32:35], v[128:131], a[44:47], v[32:35]
    v_mfma_f32_16x16x32_bf16 v[64:67], v[128:131], a[124:127], v[64:67]
    v_mfma_f32_16x16x32_bf16 v[36:39], v[132:135], a[44:47], v[36:39]
    v_mfma_f32_16x16x32_bf16 v[68:71], v[132:135], a[124:127], v[68:71]
    v_mfma_f32_16x16x32_bf16 v[40:43], v[136:139], a[44:47], v[40:43]
    v_mfma_f32_16x16x32_bf16 v[72:75], v[136:139], a[124:127], v[72:75]
    v_mfma_f32_16x16x32_bf16 v[44:47], v[140:143], a[44:47], v[44:47]
    v_mfma_f32_16x16x32_bf16 v[76:79], v[140:143], a[124:127], v[76:79]
    s_waitcnt vmcnt(8) lgkmcnt(0)
    s_barrier
    v_add_u32 v14, 92160, v2
    v_add_u32 v15, 92160, v3
    ds_read_b128 v[80:83], v14
    ds_read_b128 v[84:87], v14 offset:1024
    ds_read_b128 v[88:91], v14 offset:2048
    ds_read_b128 v[92:95], v14 offset:3072
    ds_read_b128 v[96:99], v14 offset:4096
    ds_read_b128 v[100:103], v14 offset:5120
    ds_read_b128 v[104:107], v14 offset:6144
    ds_read_b128 v[108:111], v15
    buffer_load_dwordx4 a[72:75], v2, s[8:11], s56 offen offset:2048
    s_add_u32 s41, s56, 20480
    buffer_load_dwordx4 a[152:155], v2, s[8:11], s41 offen offset:2048
    s_add_u32 m0, s72, 139264
    s_add_u32 s41, s57, 16384
    buffer_load_dwordx4 v2, s[8:11], s41 offen lds
    s_add_u32 m0, s72, 143360
    s_add_u32 s41, s57, 20480
    buffer_load_dwordx4 v2, s[8:11], s41 offen lds
    s_waitcnt lgkmcnt(0)
    v_mfma_f32_16x16x32_bf16 v[16:19], v[80:83], a[48:51], v[16:19]
    v_mfma_f32_16x16x32_bf16 v[48:51], v[80:83], a[128:131], v[48:51]
    v_add_u32 v14, 99840, v2
    v_add_u32 v15, 99840, v3
    ds_read_b128 v[112:115], v14
    ds_read_b128 v[116:119], v14 offset:1024
    v_mfma_f32_16x16x32_bf16 v[20:23], v[84:87], a[48:51], v[20:23]
    v_mfma_f32_16x16x32_bf16 v[52:55], v[84:87], a[128:131], v[52:55]
    ds_read_b128 v[120:123], v14 offset:2048
    ds_read_b128 v[124:127], v14 offset:3072
    v_mfma_f32_16x16x32_bf16 v[24:27], v[88:91], a[48:51], v[24:27]
    v_mfma_f32_16x16x32_bf16 v[56:59], v[88:91], a[128:131], v[56:59]
    ds_read_b128 v[128:131], v14 offset:4096
    ds_read_b128 v[132:135], v14 offset:5120
    v_mfma_f32_16x16x32_bf16 v[28:31], v[92:95], a[48:51], v[28:31]
    v_mfma_f32_16x16x32_bf16 v[60:63], v[92:95], a[128:131], v[60:63]
    ds_read_b128 v[136:139], v14 offset:6144
    ds_read_b128 v[140:143], v15
    v_mfma_f32_16x16x32_bf16 v[32:35], v[96:99], a[48:51], v[32:35]
    v_mfma_f32_16x16x32_bf16 v[64:67], v[96:99], a[128:131], v[64:67]
    v_mfma_f32_16x16x32_bf16 v[36:39], v[100:103], a[48:51], v[36:39]
    v_mfma_f32_16x16x32_bf16 v[68:71], v[100:103], a[128:131], v[68:71]
    v_mfma_f32_16x16x32_bf16 v[40:43], v[104:107], a[48:51], v[40:43]
    v_mfma_f32_16x16x32_bf16 v[72:75], v[104:107], a[128:131], v[72:75]
    v_mfma_f32_16x16x32_bf16 v[44:47], v[108:111], a[48:51], v[44:47]
    v_mfma_f32_16x16x32_bf16 v[76:79], v[108:111], a[128:131], v[76:79]
    buffer_load_dwordx4 a[76:79], v2, s[8:11], s56 offen offset:3072
    s_add_u32 s41, s56, 20480
    buffer_load_dwordx4 a[156:159], v2, s[8:11], s41 offen offset:3072
    s_add_u32 m0, s72, 147456
    s_add_u32 s41, s57, 24576
    buffer_load_dwordx4 v2, s[8:11], s41 offen lds
    s_cmp_ge_u32 s37, 2
    s_cbranch_scc1 K1_SKIPC4
    s_add_u32 m0, s72, 151552
    s_add_u32 s41, s57, 28672
    buffer_load_dwordx4 v2, s[8:11], s41 offen lds
K1_SKIPC4:
    s_waitcnt lgkmcnt(0)
    v_mfma_f32_16x16x32_bf16 v[16:19], v[112:115], a[52:55], v[16:19]
    v_mfma_f32_16x16x32_bf16 v[48:51], v[112:115], a[132:135], v[48:51]
    v_add_u32 v14, 107520, v2
    v_add_u32 v15, 107520, v3
    ds_read_b128 v[80:83], v14
    ds_read_b128 v[84:87], v14 offset:1024
    v_mfma_f32_16x16x32_bf16 v[20:23], v[116:119], a[52:55], v[20:23]
    v_mfma_f32_16x16x32_bf16 v[52:55], v[116:119], a[132:135], v[52:55]
    ds_read_b128 v[88:91], v14 offset:2048
    ds_read_b128 v[92:95], v14 offset:3072
    v_mfma_f32_16x16x32_bf16 v[24:27], v[120:123], a[52:55], v[24:27]
    v_mfma_f32_16x16x32_bf16 v[56:59], v[120:123], a[132:135], v[56:59]
    ds_read_b128 v[96:99], v14 offset:4096
    ds_read_b128 v[100:103], v14 offset:5120
    v_mfma_f32_16x16x32_bf16 v[28:31], v[124:127], a[52:55], v[28:31]
    v_mfma_f32_16x16x32_bf16 v[60:63], v[124:127], a[132:135], v[60:63]
    ds_read_b128 v[104:107], v14 offset:6144
    ds_read_b128 v[108:111], v15
    v_mfma_f32_16x16x32_bf16 v[32:35], v[128:131], a[52:55], v[32:35]
    v_mfma_f32_16x16x32_bf16 v[64:67], v[128:131], a[132:135], v[64:67]
    v_mfma_f32_16x16x32_bf16 v[36:39], v[132:135], a[52:55], v[36:39]
    v_mfma_f32_16x16x32_bf16 v[68:71], v[132:135], a[132:135], v[68:71]
    v_mfma_f32_16x16x32_bf16 v[40:43], v[136:139], a[52:55], v[40:43]
    v_mfma_f32_16x16x32_bf16 v[72:75], v[136:139], a[132:135], v[72:75]
    v_mfma_f32_16x16x32_bf16 v[44:47], v[140:143], a[52:55], v[44:47]
    v_mfma_f32_16x16x32_bf16 v[76:79], v[140:143], a[132:135], v[76:79]
    s_waitcnt lgkmcnt(0)
    v_mfma_f32_16x16x32_bf16 v[16:19], v[80:83], a[56:59], v[16:19]
    v_mfma_f32_16x16x32_bf16 v[48:51], v[80:83], a[136:139], v[48:51]
    v_add_u32 v14, 115200, v2
    v_add_u32 v15, 115200, v3
    ds_read_b128 v[112:115], v14
    ds_read_b128 v[116:119], v14 offset:1024
    v_mfma_f32_16x16x32_bf16 v[20:23], v[84:87], a[56:59], v[20:23]
    v_mfma_f32_16x16x32_bf16 v[52:55], v[84:87], a[136:139], v[52:55]
    ds_read_b128 v[120:123], v14 offset:2048
    ds_read_b128 v[124:127], v14 offset:3072
    v_mfma_f32_16x16x32_bf16 v[24:27], v[88:91], a[56:59], v[24:27]
    v_mfma_f32_16x16x32_bf16 v[56:59], v[88:91], a[136:139], v[56:59]
    ds_read_b128 v[128:131], v14 offset:4096
    ds_read_b128 v[132:135], v14 offset:5120
    v_mfma_f32_16x16x32_bf16 v[28:31], v[92:95], a[56:59], v[28:31]
    v_mfma_f32_16x16x32_bf16 v[60:63], v[92:95], a[136:139], v[60:63]
    ds_read_b128 v[136:139], v14 offset:6144
    ds_read_b128 v[140:143], v15
    v_mfma_f32_16x16x32_bf16 v[32:35], v[96:99], a[56:59], v[32:35]
    v_mfma_f32_16x16x32_bf16 v[64:67], v[96:99], a[136:139], v[64:67]
    v_mfma_f32_16x16x32_bf16 v[36:39], v[100:103], a[56:59], v[36:39]
    v_mfma_f32_16x16x32_bf16 v[68:71], v[100:103], a[136:139], v[68:71]
    v_mfma_f32_16x16x32_bf16 v[40:43], v[104:107], a[56:59], v[40:43]
    v_mfma_f32_16x16x32_bf16 v[72:75], v[104:107], a[136:139], v[72:75]
    v_mfma_f32_16x16x32_bf16 v[44:47], v[108:111], a[56:59], v[44:47]
    v_mfma_f32_16x16x32_bf16 v[76:79], v[108:111], a[136:139], v[76:79]
    s_waitcnt lgkmcnt(0)
    v_mfma_f32_16x16x32_bf16 v[16:19], v[112:115], a[60:63], v[16:19]
    v_mfma_f32_16x16x32_bf16 v[48:51], v[112:115], a[140:143], v[48:51]
    v_mfma_f32_16x16x32_bf16 v[20:23], v[116:119], a[60:63], v[20:23]
    v_mfma_f32_16x16x32_bf16 v[52:55], v[116:119], a[140:143], v[52:55]
    v_mfma_f32_16x16x32_bf16 v[24:27], v[120:123], a[60:63], v[24:27]
    v_mfma_f32_16x16x32_bf16 v[56:59], v[120:123], a[140:143], v[56:59]
    v_mfma_f32_16x16x32_bf16 v[28:31], v[124:127], a[60:63], v[28:31]
    v_mfma_f32_16x16x32_bf16 v[60:63], v[124:127], a[140:143], v[60:63]
    v_mfma_f32_16x16x32_bf16 v[32:35], v[128:131], a[60:63], v[32:35]
    v_mfma_f32_16x16x32_bf16 v[64:67], v[128:131], a[140:143], v[64:67]
    v_mfma_f32_16x16x32_bf16 v[36:39], v[132:135], a[60:63], v[36:39]
    v_mfma_f32_16x16x32_bf16 v[68:71], v[132:135], a[140:143], v[68:71]
    v_mfma_f32_16x16x32_bf16 v[40:43], v[136:139], a[60:63], v[40:43]
    v_mfma_f32_16x16x32_bf16 v[72:75], v[136:139], a[140:143], v[72:75]
    v_mfma_f32_16x16x32_bf16 v[44:47], v[140:143], a[60:63], v[44:47]
    v_mfma_f32_16x16x32_bf16 v[76:79], v[140:143], a[140:143], v[76:79]
    s_waitcnt vmcnt(0) lgkmcnt(0)
    s_barrier
    v_add_u32 v14, 122880, v2
    v_add_u32 v15, 122880, v3
    ds_read_b128 v[80:83], v14
    ds_read_b128 v[84:87], v14 offset:1024
    ds_read_b128 v[88:91], v14 offset:2048
    ds_read_b128 v[92:95], v14 offset:3072
    ds_read_b128 v[96:99], v14 offset:4096
    ds_read_b128 v[100:103], v14 offset:5120
    ds_read_b128 v[104:107], v14 offset:6144
    ds_read_b128 v[108:111], v15
    s_waitcnt lgkmcnt(0)
    v_mfma_f32_16x16x32_bf16 v[16:19], v[80:83], a[64:67], v[16:19]
    v_mfma_f32_16x16x32_bf16 v[48:51], v[80:83], a[144:147], v[48:51]
    v_add_u32 v14, 130560, v2
    v_add_u32 v15, 130560, v3
    ds_read_b128 v[112:115], v14
    ds_read_b128 v[116:119], v14 offset:1024
    v_mfma_f32_16x16x32_bf16 v[20:23], v[84:87], a[64:67], v[20:23]
    v_mfma_f32_16x16x32_bf16 v[52:55], v[84:87], a[144:147], v[52:55]
    ds_read_b128 v[120:123], v14 offset:2048
    ds_read_b128 v[124:127], v14 offset:3072
    v_mfma_f32_16x16x32_bf16 v[24:27], v[88:91], a[64:67], v[24:27]
    v_mfma_f32_16x16x32_bf16 v[56:59], v[88:91], a[144:147], v[56:59]
    ds_read_b128 v[128:131], v14 offset:4096
    ds_read_b128 v[132:135], v14 offset:5120
    v_mfma_f32_16x16x32_bf16 v[28:31], v[92:95], a[64:67], v[28:31]
    v_mfma_f32_16x16x32_bf16 v[60:63], v[92:95], a[144:147], v[60:63]
    ds_read_b128 v[136:139], v14 offset:6144
    ds_read_b128 v[140:143], v15
    v_mfma_f32_16x16x32_bf16 v[32:35], v[96:99], a[64:67], v[32:35]
    v_mfma_f32_16x16x32_bf16 v[64:67], v[96:99], a[144:147], v[64:67]
    v_mfma_f32_16x16x32_bf16 v[36:39], v[100:103], a[64:67], v[36:39]
    v_mfma_f32_16x16x32_bf16 v[68:71], v[100:103], a[144:147], v[68:71]
    v_mfma_f32_16x16x32_bf16 v[40:43], v[104:107], a[64:67], v[40:43]
    v_mfma_f32_16x16x32_bf16 v[72:75], v[104:107], a[144:147], v[72:75]
    v_mfma_f32_16x16x32_bf16 v[44:47], v[108:111], a[64:67], v[44:47]
    v_mfma_f32_16x16x32_bf16 v[76:79], v[108:111], a[144:147], v[76:79]
    s_waitcnt lgkmcnt(0)
    v_mfma_f32_16x16x32_bf16 v[16:19], v[112:115], a[68:71], v[16:19]
    v_mfma_f32_16x16x32_bf16 v[48:51], v[112:115], a[148:151], v[48:51]
    v_add_u32 v14, 138240, v2
    v_add_u32 v15, 138240, v3
    ds_read_b128 v[80:83], v14
    ds_read_b128 v[84:87], v14 offset:1024
    v_mfma_f32_16x16x32_bf16 v[20:23], v[116:119], a[68:71], v[20:23]
    v_mfma_f32_16x16x32_bf16 v[52:55], v[116:119], a[148:151], v[52:55]
    ds_read_b128 v[88:91], v14 offset:2048
    ds_read_b128 v[92:95], v14 offset:3072
    v_mfma_f32_16x16x32_bf16 v[24:27], v[120:123], a[68:71], v[24:27]
    v_mfma_f32_16x16x32_bf16 v[56:59], v[120:123], a[148:151], v[56:59]
    ds_read_b128 v[96:99], v14 offset:4096
    ds_read_b128 v[100:103], v14 offset:5120
    v_mfma_f32_16x16x32_bf16 v[28:31], v[124:127], a[68:71], v[28:31]
    v_mfma_f32_16x16x32_bf16 v[60:63], v[124:127], a[148:151], v[60:63]
    ds_read_b128 v[104:107], v14 offset:6144
    ds_read_b128 v[108:111], v15
    v_mfma_f32_16x16x32_bf16 v[32:35], v[128:131], a[68:71], v[32:35]
    v_mfma_f32_16x16x32_bf16 v[64:67], v[128:131], a[148:151], v[64:67]
    v_mfma_f32_16x16x32_bf16 v[36:39], v[132:135], a[68:71], v[36:39]
    v_mfma_f32_16x16x32_bf16 v[68:71], v[132:135], a[148:151], v[68:71]
    v_mfma_f32_16x16x32_bf16 v[40:43], v[136:139], a[68:71], v[40:43]
    v_mfma_f32_16x16x32_bf16 v[72:75], v[136:139], a[148:151], v[72:75]
    v_mfma_f32_16x16x32_bf16 v[44:47], v[140:143], a[68:71], v[44:47]
    v_mfma_f32_16x16x32_bf16 v[76:79], v[140:143], a[148:151], v[76:79]
    s_waitcnt lgkmcnt(0)
    v_mfma_f32_16x16x32_bf16 v[16:19], v[80:83], a[72:75], v[16:19]
    v_mfma_f32_16x16x32_bf16 v[48:51], v[80:83], a[152:155], v[48:51]
    v_add_u32 v14, 145920, v2
    v_add_u32 v15, 145920, v3
    ds_read_b128 v[112:115], v14
    ds_read_b128 v[116:119], v14 offset:1024
    v_mfma_f32_16x16x32_bf16 v[20:23], v[84:87], a[72:75], v[20:23]
    v_mfma_f32_16x16x32_bf16 v[52:55], v[84:87], a[152:155], v[52:55]
    ds_read_b128 v[120:123], v14 offset:2048
    ds_read_b128 v[124:127], v14 offset:3072
    v_mfma_f32_16x16x32_bf16 v[24:27], v[88:91], a[72:75], v[24:27]
    v_mfma_f32_16x16x32_bf16 v[56:59], v[88:91], a[152:155], v[56:59]
    ds_read_b128 v[128:131], v14 offset:4096
    ds_read_b128 v[132:135], v14 offset:5120
    v_mfma_f32_16x16x32_bf16 v[28:31], v[92:95], a[72:75], v[28:31]
    v_mfma_f32_16x16x32_bf16 v[60:63], v[92:95], a[152:155], v[60:63]
    ds_read_b128 v[136:139], v14 offset:6144
    ds_read_b128 v[140:143], v15
    v_mfma_f32_16x16x32_bf16 v[32:35], v[96:99], a[72:75], v[32:35]
    v_mfma_f32_16x16x32_bf16 v[64:67], v[96:99], a[152:155], v[64:67]
    v_mfma_f32_16x16x32_bf16 v[36:39], v[100:103], a[72:75], v[36:39]
    v_mfma_f32_16x16x32_bf16 v[68:71], v[100:103], a[152:155], v[68:71]
    v_mfma_f32_16x16x32_bf16 v[40:43], v[104:107], a[72:75], v[40:43]
    v_mfma_f32_16x16x32_bf16 v[72:75], v[104:107], a[152:155], v[72:75]
    v_mfma_f32_16x16x32_bf16 v[44:47], v[108:111], a[72:75], v[44:47]
    v_mfma_f32_16x16x32_bf16 v[76:79], v[108:111], a[152:155], v[76:79]
    s_waitcnt lgkmcnt(0)
    v_mfma_f32_16x16x32_bf16 v[16:19], v[112:115], a[76:79], v[16:19]
    v_mfma_f32_16x16x32_bf16 v[48:51], v[112:115], a[156:159], v[48:51]
    v_mfma_f32_16x16x32_bf16 v[20:23], v[116:119], a[76:79], v[20:23]
    v_mfma_f32_16x16x32_bf16 v[52:55], v[116:119], a[156:159], v[52:55]
    v_mfma_f32_16x16x32_bf16 v[24:27], v[120:123], a[76:79], v[24:27]
    v_mfma_f32_16x16x32_bf16 v[56:59], v[120:123], a[156:159], v[56:59]
    v_mfma_f32_16x16x32_bf16 v[28:31], v[124:127], a[76:79], v[28:31]
    v_mfma_f32_16x16x32_bf16 v[60:63], v[124:127], a[156:159], v[60:63]
    v_mfma_f32_16x16x32_bf16 v[32:35], v[128:131], a[76:79], v[32:35]
    v_mfma_f32_16x16x32_bf16 v[64:67], v[128:131], a[156:159], v[64:67]
    v_mfma_f32_16x16x32_bf16 v[36:39], v[132:135], a[76:79], v[36:39]
    v_mfma_f32_16x16x32_bf16 v[68:71], v[132:135], a[156:159], v[68:71]
    v_mfma_f32_16x16x32_bf16 v[40:43], v[136:139], a[76:79], v[40:43]
    v_mfma_f32_16x16x32_bf16 v[72:75], v[136:139], a[156:159], v[72:75]
    v_mfma_f32_16x16x32_bf16 v[44:47], v[140:143], a[76:79], v[44:47]
    v_mfma_f32_16x16x32_bf16 v[76:79], v[140:143], a[156:159], v[76:79]
    s_lshr_b32 s41, s2, 3
    s_mul_i32 s42, s41, 25600
    s_mul_i32 s43, s37, 6400
    s_add_u32 s42, s42, s43
    s_add_u32 s66, s42, 1048576
    s_mov_b32 s12, s24
    s_mov_b32 s13, s25
    s_mov_b32 s14, 1966080
    s_mov_b32 s15, 0x20000
    s_mov_b32 s16, s26
    s_mov_b32 s17, s27
    s_mov_b32 s18, 1966080
    s_mov_b32 s19, 0x20000
    s_mov_b32 s20, s28
    s_mov_b32 s21, s29
    s_mov_b32 s22, 1966080
    s_mov_b32 s23, 0x20000
    s_min_u32 s41, s41, 23
    s_lshr_b32 s42, s41, 2
    s_lshl_b32 s42, s42, 3
    s_and_b32 s43, s2, 7
    s_add_u32 s42, s42, s43
    s_and_b32 s43, s41, 3
    s_mul_i32 s46, s43, 160
    s_mul_i32 s47, s37, 40
    s_add_u32 s46, s46, s47
    v_lshrrev_b32 v248, 2, v1
    v_add_u32 v248, s46, v248
    s_movk_i32 s47, 3072
    v_mul_lo_u32 v248, v248, s47
    v_and_b32 v249, 3, v1
    v_lshlrev_b32 v249, 4, v249
    s_lshl_b32 s47, s42, 6
    v_add3_u32 v248, v248, v249, s47
    s_lshl_b32 s46, s42, 5
    s_lshl_b32 s47, s43, 3
    s_add_u32 s46, s46, s47
    s_mul_i32 s46, s46, 1280
    s_mul_i32 s47, s37, 2560
    s_add_u32 s67, s46, s47
    s_mov_b32 s68, 49152
    s_mov_b32 s69, 73728
    v_and_b32 v9, 15, v1
    v_mul_u32_u24 v10, 288, v9
    v_lshrrev_b32 v11, 4, v1
    v_lshrrev_b32 v12, 1, v11
    v_mul_u32_u24 v12, 40, v12
    v_and_b32 v13, 1, v11
    v_lshlrev_b32 v13, 3, v13
    v_add3_u32 v12, v12, v13, v10
    v_add_u32 v12, 160, v12
    v_mul_u32_u24 v13, 80, v11
    v_add_u32 v13, v13, v10
    v_subrev_u32 v13, 160, v13
    v_and_b32 v14, 3, v1
    v_bfe_u32 v15, v1, 2, 2
    v_mul_u32_u24 v15, 40, v15
    v_and_b32 v8, 1, v11
    v_mul_u32_u24 v8, 800, v8
    v_add_u32 v15, v15, v8
    v_add_u32 v15, 155648, v15
    v_mov_b32 v8, 157248
    v_cmp_eq_u32 vcc, v14, v11
    s_nop 1
    v_cndmask_b32 v15, v8, v15, vcc
    v_mul_u32_u24 v7, 1280, v11
    v_lshlrev_b32 v9, 4, v9
    v_add_u32 v7, v7, v9
    s_barrier
    v_cvt_pk_bf16_f32 v204, v16, v17
    v_cvt_pk_bf16_f32 v205, v18, v19
    v_cvt_pk_bf16_f32 v206, v20, v21
    v_cvt_pk_bf16_f32 v207, v22, v23
    v_cvt_pk_bf16_f32 v208, v24, v25
    v_cvt_pk_bf16_f32 v209, v26, v27
    v_cvt_pk_bf16_f32 v210, v28, v29
    v_cvt_pk_bf16_f32 v211, v30, v31
    v_cvt_pk_bf16_f32 v212, v32, v33
    v_cvt_pk_bf16_f32 v213, v34, v35
    v_mov_b32 v214, 0
    v_mov_b32 v215, 0
    v_cvt_pk_bf16_f32 v216, v36, v37
    v_cvt_pk_bf16_f32 v217, v38, v39
    v_cvt_pk_bf16_f32 v218, v40, v41
    v_cvt_pk_bf16_f32 v219, v42, v43
    v_cvt_pk_bf16_f32 v220, v44, v45
    v_cvt_pk_bf16_f32 v221, v46, v47
    s_lshl_b32 s39, s37, 1
    s_add_u32 s39, s39, 0
    s_mul_i32 s38, s39, 4608
    s_add_u32 s38, s38, 0
    v_add_u32 v4, s38, v12
    v_add_u32 v100, s38, v13
    v_add_u32 v6, s38, v10
    ds_write_b64 v4, v[216:217]
    ds_write_b64 v4, v[218:219] offset:16
    s_mov_b32 exec_lo, 0x0000ffff
    s_mov_b32 exec_hi, 0x0000ffff
    ds_write_b64 v4, v[220:221] offset:32
    v_mov_b32 v222, 0x00003f80
    v_mov_b32 v223, 0
    ds_write_b64 v6, v[222:223] offset:240
    s_mov_b64 exec, -1
    s_add_u32 s70, s66, 0
    buffer_load_dwordx4 v[252:255], v2, s[8:11], s70 offen
    s_add_u32 s70, s66, 1024
    buffer_load_dwordx4 v[252:255], v2, s[8:11], s70 offen
    v_cvt_pk_bf16_f32 v80, v48, v49
    v_cvt_pk_bf16_f32 v81, v50, v51
    v_cvt_pk_bf16_f32 v82, v52, v53
    v_cvt_pk_bf16_f32 v83, v54, v55
    v_cvt_pk_bf16_f32 v84, v56, v57
    v_cvt_pk_bf16_f32 v85, v58, v59
    v_cvt_pk_bf16_f32 v86, v60, v61
    v_cvt_pk_bf16_f32 v87, v62, v63
    v_cvt_pk_bf16_f32 v88, v64, v65
    v_cvt_pk_bf16_f32 v89, v66, v67
    v_mov_b32 v90, 0
    v_mov_b32 v91, 0
    v_cvt_pk_bf16_f32 v92, v68, v69
    v_cvt_pk_bf16_f32 v93, v70, v71
    v_cvt_pk_bf16_f32 v94, v72, v73
    v_cvt_pk_bf16_f32 v95, v74, v75
    v_cvt_pk_bf16_f32 v96, v76, v77
    v_cvt_pk_bf16_f32 v97, v78, v79
    s_lshl_b32 s39, s37, 1
    s_add_u32 s39, s39, 1
    s_mul_i32 s38, s39, 4608
    s_add_u32 s38, s38, 0
    v_add_u32 v4, s38, v12
    v_add_u32 v101, s38, v13
    v_add_u32 v6, s38, v10
    ds_write_b64 v4, v[92:93]
    ds_write_b64 v4, v[94:95] offset:16
    s_mov_b32 exec_lo, 0x0000ffff
    s_mov_b32 exec_hi, 0x0000ffff
    ds_write_b64 v4, v[96:97] offset:32
    v_mov_b32 v222, 0x00003f80
    v_mov_b32 v223, 0
    ds_write_b64 v6, v[222:223] offset:240
    s_mov_b64 exec, -1
    s_add_u32 s70, s66, 2048
    buffer_load_dwordx4 v[252:255], v2, s[8:11], s70 offen
    s_add_u32 s70, s66, 3072
    buffer_load_dwordx4 v[252:255], v2, s[8:11], s70 offen
    ds_read_b64_tr_b16 v[224:225], v15 offset:0
    ds_read_b64_tr_b16 v[226:227], v15 offset:160
    ds_read_b64_tr_b16 v[228:229], v15 offset:320
    ds_read_b64_tr_b16 v[230:231], v15 offset:480
    ds_read_b64_tr_b16 v[232:233], v15 offset:640
    v_mov_b32 v234, 0
    v_mov_b32 v235, 0
    ds_read_b64_tr_b16 v[236:237], v15 offset:8
    ds_read_b64_tr_b16 v[238:239], v15 offset:168
    ds_read_b64_tr_b16 v[240:241], v15 offset:328
    ds_read_b64_tr_b16 v[242:243], v15 offset:488
    ds_read_b64_tr_b16 v[244:245], v15 offset:648
    v_mov_b32 v246, 0
    v_mov_b32 v247, 0
    s_waitcnt lgkmcnt(5)
    v_mfma_f32_16x16x32_bf16 v[16:19], v[224:227], v[204:207], 0
    v_mfma_f32_16x16x32_bf16 v[16:19], v[228:231], v[208:211], v[16:19]
    v_mfma_f32_16x16x32_bf16 v[16:19], v[232:235], v[212:215], v[16:19]
    v_mfma_f32_16x16x32_bf16 v[48:51], v[224:227], v[80:83], 0
    v_mfma_f32_16x16x32_bf16 v[48:51], v[228:231], v[84:87], v[48:51]
    v_mfma_f32_16x16x32_bf16 v[48:51], v[232:235], v[88:91], v[48:51]
    ds_read_b64_tr_b16 v[224:225], v15 offset:16
    ds_read_b64_tr_b16 v[226:227], v15 offset:176
    ds_read_b64_tr_b16 v[228:229], v15 offset:336
    ds_read_b64_tr_b16 v[230:231], v15 offset:496
    ds_read_b64_tr_b16 v[232:233], v15 offset:656
    v_mov_b32 v234, 0
    v_mov_b32 v235, 0
    s_waitcnt lgkmcnt(5)
    v_mfma_f32_16x16x32_bf16 v[20:23], v[236:239], v[204:207], 0
    v_mfma_f32_16x16x32_bf16 v[20:23], v[240:243], v[208:211], v[20:23]
    v_mfma_f32_16x16x32_bf16 v[20:23], v[244:247], v[212:215], v[20:23]
    v_mfma_f32_16x16x32_bf16 v[52:55], v[236:239], v[80:83], 0
    v_mfma_f32_16x16x32_bf16 v[52:55], v[240:243], v[84:87], v[52:55]
    v_mfma_f32_16x16x32_bf16 v[52:55], v[244:247], v[88:91], v[52:55]
    ds_read_b64_tr_b16 v[236:237], v15 offset:24
    ds_read_b64_tr_b16 v[238:239], v15 offset:184
    ds_read_b64_tr_b16 v[240:241], v15 offset:344
    ds_read_b64_tr_b16 v[242:243], v15 offset:504
    ds_read_b64_tr_b16 v[244:245], v15 offset:664
    v_mov_b32 v246, 0
    v_mov_b32 v247, 0
    s_waitcnt lgkmcnt(5)
    v_mfma_f32_16x16x32_bf16 v[24:27], v[224:227], v[204:207], 0
    v_mfma_f32_16x16x32_bf16 v[24:27], v[228:231], v[208:211], v[24:27]
    v_mfma_f32_16x16x32_bf16 v[24:27], v[232:235], v[212:215], v[24:27]
    v_mfma_f32_16x16x32_bf16 v[56:59], v[224:227], v[80:83], 0
    v_mfma_f32_16x16x32_bf16 v[56:59], v[228:231], v[84:87], v[56:59]
    v_mfma_f32_16x16x32_bf16 v[56:59], v[232:235], v[88:91], v[56:59]
    ds_read_b64_tr_b16 v[224:225], v15 offset:32
    ds_read_b64_tr_b16 v[226:227], v15 offset:192
    ds_read_b64_tr_b16 v[228:229], v15 offset:352
    ds_read_b64_tr_b16 v[230:231], v15 offset:512
    ds_read_b64_tr_b16 v[232:233], v15 offset:672
    v_mov_b32 v234, 0
    v_mov_b32 v235, 0
    s_waitcnt lgkmcnt(5)
    v_mfma_f32_16x16x32_bf16 v[28:31], v[236:239], v[204:207], 0
    v_mfma_f32_16x16x32_bf16 v[28:31], v[240:243], v[208:211], v[28:31]
    v_mfma_f32_16x16x32_bf16 v[28:31], v[244:247], v[212:215], v[28:31]
    v_mfma_f32_16x16x32_bf16 v[60:63], v[236:239], v[80:83], 0
    v_mfma_f32_16x16x32_bf16 v[60:63], v[240:243], v[84:87], v[60:63]
    v_mfma_f32_16x16x32_bf16 v[60:63], v[244:247], v[88:91], v[60:63]
    s_waitcnt lgkmcnt(0)
    v_mfma_f32_16x16x32_bf16 v[32:35], v[224:227], v[204:207], 0
    v_mfma_f32_16x16x32_bf16 v[32:35], v[228:231], v[208:211], v[32:35]
    v_mfma_f32_16x16x32_bf16 v[32:35], v[232:235], v[212:215], v[32:35]
    v_mfma_f32_16x16x32_bf16 v[64:67], v[224:227], v[80:83], 0
    v_mfma_f32_16x16x32_bf16 v[64:67], v[228:231], v[84:87], v[64:67]
    v_mfma_f32_16x16x32_bf16 v[64:67], v[232:235], v[88:91], v[64:67]
    s_add_u32 s70, s66, 4096
    buffer_load_dwordx4 v[252:255], v2, s[8:11], s70 offen
    s_add_u32 s70, s66, 5120
    buffer_load_dwordx4 v[252:255], v2, s[8:11], s70 offen
    s_nop 5
    s_lshl_b32 s39, s37, 1
    s_add_u32 s39, s39, 0
    s_lshl_b32 s40, s32, 3
    s_add_u32 s39, s39, s40
    s_lshl_b32 s39, s39, 5
    s_lshl_b32 s40, s33, 1
    s_add_u32 s39, s39, s40
    s_mul_i32 s39, s39, 1280
    s_add_u32 s39, s39, 2097152
    s_add_u32 s70, s66, 6144
    buffer_load_dwordx4 v[252:255], v2, s[8:11], s70 offen
    buffer_load_dwordx4 v[252:255], v248, s[12:15], 0 offen
    buffer_load_dwordx4 v[252:255], v248, s[16:19], 0 offen
    v_cvt_pk_bf16_f32 v144, v16, v17
    v_cvt_pk_bf16_f32 v145, v18, v19
    v_cvt_pk_bf16_f32 v146, v20, v21
    v_cvt_pk_bf16_f32 v147, v22, v23
    v_cvt_pk_bf16_f32 v148, v24, v25
    v_cvt_pk_bf16_f32 v149, v26, v27
    v_cvt_pk_bf16_f32 v150, v28, v29
    v_cvt_pk_bf16_f32 v151, v30, v31
    v_cvt_pk_bf16_f32 v152, v32, v33
    v_cvt_pk_bf16_f32 v153, v34, v35
    v_lshlrev_b32 v16, 16, v144
    v_and_b32 v17, 0xffff0000, v144
    v_lshlrev_b32 v18, 16, v145
    v_and_b32 v19, 0xffff0000, v145
    v_lshlrev_b32 v20, 16, v146
    v_and_b32 v21, 0xffff0000, v146
    v_lshlrev_b32 v22, 16, v147
    v_and_b32 v23, 0xffff0000, v147
    v_lshlrev_b32 v24, 16, v148
    v_and_b32 v25, 0xffff0000, v148
    v_lshlrev_b32 v26, 16, v149
    v_and_b32 v27, 0xffff0000, v149
    v_lshlrev_b32 v28, 16, v150
    v_and_b32 v29, 0xffff0000, v150
    v_lshlrev_b32 v30, 16, v151
    v_and_b32 v31, 0xffff0000, v151
    v_lshlrev_b32 v32, 16, v152
    v_and_b32 v33, 0xffff0000, v152
    v_lshlrev_b32 v34, 16, v153
    v_and_b32 v35, 0xffff0000, v153
    v_max3_f32 v154, v16, v17, v18
    v_min3_f32 v155, v16, v17, v18
    v_max3_f32 v154, v154, v19, v20
    v_min3_f32 v155, v155, v19, v20
    v_max3_f32 v154, v154, v21, v22
    v_min3_f32 v155, v155, v21, v22
    v_max3_f32 v154, v154, v23, v24
    v_min3_f32 v155, v155, v23, v24
    v_max3_f32 v154, v154, v25, v26
    v_min3_f32 v155, v155, v25, v26
    v_max3_f32 v154, v154, v27, v28
    v_min3_f32 v155, v155, v27, v28
    v_max3_f32 v154, v154, v29, v30
    v_min3_f32 v155, v155, v29, v30
    v_max3_f32 v154, v154, v31, v32
    v_min3_f32 v155, v155, v31, v32
    v_max3_f32 v154, v154, v33, v34
    v_min3_f32 v155, v155, v33, v34
    v_max_f32 v154, v154, v35
    v_min_f32 v155, v155, v35
    v_mul_f32 v156, s44, v154
    v_mul_f32 v158, s44, v155
    v_mov_b32 v157, v156
    v_mov_b32 v159, v158
    v_pk_fma_f32 v[164:165], v[16:17], s[44:45], v[158:159] neg_lo:[1,0,0] neg_hi:[1,0,0]
    v_pk_fma_f32 v[16:17], v[16:17], s[44:45], v[156:157] neg_lo:[0,0,1] neg_hi:[0,0,1]
    v_pk_fma_f32 v[166:167], v[18:19], s[44:45], v[158:159] neg_lo:[1,0,0] neg_hi:[1,0,0]
    v_pk_fma_f32 v[18:19], v[18:19], s[44:45], v[156:157] neg_lo:[0,0,1] neg_hi:[0,0,1]
    v_pk_fma_f32 v[168:169], v[20:21], s[44:45], v[158:159] neg_lo:[1,0,0] neg_hi:[1,0,0]
    v_pk_fma_f32 v[20:21], v[20:21], s[44:45], v[156:157] neg_lo:[0,0,1] neg_hi:[0,0,1]
    v_pk_fma_f32 v[170:171], v[22:23], s[44:45], v[158:159] neg_lo:[1,0,0] neg_hi:[1,0,0]
    v_pk_fma_f32 v[22:23], v[22:23], s[44:45], v[156:157] neg_lo:[0,0,1] neg_hi:[0,0,1]
    v_pk_fma_f32 v[172:173], v[24:25], s[44:45], v[158:159] neg_lo:[1,0,0] neg_hi:[1,0,0]
    v_pk_fma_f32 v[24:25], v[24:25], s[44:45], v[156:157] neg_lo:[0,0,1] neg_hi:[0,0,1]
    v_pk_fma_f32 v[174:175], v[26:27], s[44:45], v[158:159] neg_lo:[1,0,0] neg_hi:[1,0,0]
    v_pk_fma_f32 v[26:27], v[26:27], s[44:45], v[156:157] neg_lo:[0,0,1] neg_hi:[0,0,1]
    v_pk_fma_f32 v[176:177], v[28:29], s[44:45], v[158:159] neg_lo:[1,0,0] neg_hi:[1,0,0]
    v_pk_fma_f32 v[28:29], v[28:29], s[44:45], v[156:157] neg_lo:[0,0,1] neg_hi:[0,0,1]
    v_pk_fma_f32 v[178:179], v[30:31], s[44:45], v[158:159] neg_lo:[1,0,0] neg_hi:[1,0,0]
    v_pk_fma_f32 v[30:31], v[30:31], s[44:45], v[156:157] neg_lo:[0,0,1] neg_hi:[0,0,1]
    v_pk_fma_f32 v[180:181], v[32:33], s[44:45], v[158:159] neg_lo:[1,0,0] neg_hi:[1,0,0]
    v_pk_fma_f32 v[32:33], v[32:33], s[44:45], v[156:157] neg_lo:[0,0,1] neg_hi:[0,0,1]
    v_pk_fma_f32 v[182:183], v[34:35], s[44:45], v[158:159] neg_lo:[1,0,0] neg_hi:[1,0,0]
    v_pk_fma_f32 v[34:35], v[34:35], s[44:45], v[156:157] neg_lo:[0,0,1] neg_hi:[0,0,1]
    v_exp_f32 v164, v164
    v_exp_f32 v16, v16
    v_exp_f32 v165, v165
    v_exp_f32 v17, v17
    v_exp_f32 v166, v166
    v_exp_f32 v18, v18
    v_exp_f32 v167, v167
    v_exp_f32 v19, v19
    v_exp_f32 v168, v168
    v_exp_f32 v20, v20
    v_exp_f32 v169, v169
    v_exp_f32 v21, v21
    v_exp_f32 v170, v170
    v_exp_f32 v22, v22
    buffer_load_dwordx4 v[252:255], v248, s[12:15], s68 offen
    v_exp_f32 v171, v171
    v_exp_f32 v23, v23
    v_exp_f32 v172, v172
    v_exp_f32 v24, v24
    v_exp_f32 v173, v173
    v_exp_f32 v25, v25
    v_exp_f32 v174, v174
    v_exp_f32 v26, v26
    v_exp_f32 v175, v175
    v_exp_f32 v27, v27
    v_exp_f32 v176, v176
    v_exp_f32 v28, v28
    v_exp_f32 v177, v177
    v_exp_f32 v29, v29
    buffer_load_dwordx4 v[252:255], v248, s[16:19], s68 offen
    v_exp_f32 v178, v178
    v_exp_f32 v30, v30
    v_exp_f32 v179, v179
    v_exp_f32 v31, v31
    v_exp_f32 v180, v180
    v_exp_f32 v32, v32
    v_exp_f32 v181, v181
    v_exp_f32 v33, v33
    v_exp_f32 v182, v182
    v_exp_f32 v34, v34
    v_exp_f32 v183, v183
    v_exp_f32 v35, v35
    s_nop 0
    v_pk_add_f32 v[158:159], v[164:165], v[166:167]
    v_pk_add_f32 v[156:157], v[16:17], v[18:19]
    v_pk_add_f32 v[158:159], v[158:159], v[168:169]
    v_pk_add_f32 v[156:157], v[156:157], v[20:21]
    v_pk_add_f32 v[158:159], v[158:159], v[170:171]
    v_pk_add_f32 v[156:157], v[156:157], v[22:23]
    v_pk_add_f32 v[158:159], v[158:159], v[172:173]
    v_pk_add_f32 v[156:157], v[156:157], v[24:25]
    v_pk_add_f32 v[158:159], v[158:159], v[174:175]
    v_pk_add_f32 v[156:157], v[156:157], v[26:27]
    v_pk_add_f32 v[158:159], v[158:159], v[176:177]
    v_pk_add_f32 v[156:157], v[156:157], v[28:29]
    v_pk_add_f32 v[158:159], v[158:159], v[178:179]
    v_pk_add_f32 v[156:157], v[156:157], v[30:31]
    v_pk_add_f32 v[158:159], v[158:159], v[180:181]
    v_pk_add_f32 v[156:157], v[156:157], v[32:33]
    v_pk_add_f32 v[158:159], v[158:159], v[182:183]
    v_pk_add_f32 v[156:157], v[156:157], v[34:35]
    v_add_f32 v158, v158, v159
    v_add_f32 v156, v156, v157
    v_rcp_f32 v158, v158
    v_rcp_f32 v156, v156
    s_nop 0
    v_mov_b32 v159, v158
    v_mov_b32 v157, v156
    v_pk_mul_f32 v[16:17], v[16:17], v[156:157]
    v_pk_mul_f32 v[164:165], v[164:165], v[158:159]
    v_pk_mul_f32 v[18:19], v[18:19], v[156:157]
    v_pk_mul_f32 v[166:167], v[166:167], v[158:159]
    v_pk_mul_f32 v[20:21], v[20:21], v[156:157]
    v_pk_mul_f32 v[168:169], v[168:169], v[158:159]
    v_pk_mul_f32 v[22:23], v[22:23], v[156:157]
    v_pk_mul_f32 v[170:171], v[170:171], v[158:159]
    v_pk_mul_f32 v[24:25], v[24:25], v[156:157]
    v_pk_mul_f32 v[172:173], v[172:173], v[158:159]
    v_pk_mul_f32 v[26:27], v[26:27], v[156:157]
    v_pk_mul_f32 v[174:175], v[174:175], v[158:159]
    v_pk_mul_f32 v[28:29], v[28:29], v[156:157]
    v_pk_mul_f32 v[176:177], v[176:177], v[158:159]
    v_pk_mul_f32 v[30:31], v[30:31], v[156:157]
    v_pk_mul_f32 v[178:179], v[178:179], v[158:159]
    v_pk_mul_f32 v[32:33], v[32:33], v[156:157]
    v_pk_mul_f32 v[180:181], v[180:181], v[158:159]
    v_pk_mul_f32 v[34:35], v[34:35], v[156:157]
    v_pk_mul_f32 v[182:183], v[182:183], v[158:159]
    v_cvt_pk_bf16_f32 v184, v16, v17
    v_cvt_pk_bf16_f32 v185, v18, v19
    v_cvt_pk_bf16_f32 v186, v20, v21
    v_cvt_pk_bf16_f32 v187, v22, v23
    v_cvt_pk_bf16_f32 v188, v24, v25
    v_cvt_pk_bf16_f32 v189, v26, v27
    v_cvt_pk_bf16_f32 v190, v28, v29
    v_cvt_pk_bf16_f32 v191, v30, v31
    v_cvt_pk_bf16_f32 v192, v32, v33
    v_cvt_pk_bf16_f32 v193, v34, v35
    v_cvt_pk_bf16_f32 v194, v164, v165
    v_cvt_pk_bf16_f32 v195, v166, v167
    v_cvt_pk_bf16_f32 v196, v168, v169
    v_cvt_pk_bf16_f32 v197, v170, v171
    v_cvt_pk_bf16_f32 v198, v172, v173
    v_cvt_pk_bf16_f32 v199, v174, v175
    v_cvt_pk_bf16_f32 v200, v176, v177
    v_cvt_pk_bf16_f32 v201, v178, v179
    v_cvt_pk_bf16_f32 v202, v180, v181
    v_cvt_pk_bf16_f32 v203, v182, v183
    s_mov_b32 exec_lo, 0
    ds_write_b128 v100, v[184:187] offset:0
    ds_write_b128 v100, v[188:191] offset:16
    ds_write_b128 v100, v[192:195] offset:32
    ds_write_b128 v100, v[196:199] offset:48
    ds_write_b128 v100, v[200:203] offset:64
    s_mov_b32 exec_lo, -1
    s_mov_b32 exec_hi, 0
    buffer_store_dwordx4 v[184:187], v7, s[8:11], s39 offen offset:0
    buffer_store_dwordx4 v[188:191], v7, s[8:11], s39 offen offset:256
    buffer_store_dwordx4 v[192:195], v7, s[8:11], s39 offen offset:512
    buffer_store_dwordx4 v[196:199], v7, s[8:11], s39 offen offset:768
    buffer_store_dwordx4 v[200:203], v7, s[8:11], s39 offen offset:1024
    s_mov_b64 exec, -1
    s_nop 1
    s_lshl_b32 s39, s37, 1
    s_add_u32 s39, s39, 1
    s_lshl_b32 s40, s32, 3
    s_add_u32 s39, s39, s40
    s_lshl_b32 s39, s39, 5
    s_lshl_b32 s40, s33, 1
    s_add_u32 s39, s39, s40
    s_mul_i32 s39, s39, 1280
    s_add_u32 s39, s39, 2097152
    buffer_load_dwordx4 v[252:255], v248, s[12:15], s69 offen
    buffer_load_dwordx4 v[252:255], v248, s[16:19], s69 offen
    buffer_load_dwordx4 v[252:255], v2, s[20:23], s67 offen offset:0
    v_cvt_pk_bf16_f32 v144, v48, v49
    v_cvt_pk_bf16_f32 v145, v50, v51
    v_cvt_pk_bf16_f32 v146, v52, v53
    v_cvt_pk_bf16_f32 v147, v54, v55
    v_cvt_pk_bf16_f32 v148, v56, v57
    v_cvt_pk_bf16_f32 v149, v58, v59
    v_cvt_pk_bf16_f32 v150, v60, v61
    v_cvt_pk_bf16_f32 v151, v62, v63
    v_cvt_pk_bf16_f32 v152, v64, v65
    v_cvt_pk_bf16_f32 v153, v66, v67
    v_lshlrev_b32 v48, 16, v144
    v_and_b32 v49, 0xffff0000, v144
    v_lshlrev_b32 v50, 16, v145
    v_and_b32 v51, 0xffff0000, v145
    v_lshlrev_b32 v52, 16, v146
    v_and_b32 v53, 0xffff0000, v146
    v_lshlrev_b32 v54, 16, v147
    v_and_b32 v55, 0xffff0000, v147
    v_lshlrev_b32 v56, 16, v148
    v_and_b32 v57, 0xffff0000, v148
    v_lshlrev_b32 v58, 16, v149
    v_and_b32 v59, 0xffff0000, v149
    v_lshlrev_b32 v60, 16, v150
    v_and_b32 v61, 0xffff0000, v150
    v_lshlrev_b32 v62, 16, v151
    v_and_b32 v63, 0xffff0000, v151
    v_lshlrev_b32 v64, 16, v152
    v_and_b32 v65, 0xffff0000, v152
    v_lshlrev_b32 v66, 16, v153
    v_and_b32 v67, 0xffff0000, v153
    v_max3_f32 v154, v48, v49, v50
    v_min3_f32 v155, v48, v49, v50
    v_max3_f32 v154, v154, v51, v52
    v_min3_f32 v155, v155, v51, v52
    v_max3_f32 v154, v154, v53, v54
    v_min3_f32 v155, v155, v53, v54
    v_max3_f32 v154, v154, v55, v56
    v_min3_f32 v155, v155, v55, v56
    v_max3_f32 v154, v154, v57, v58
    v_min3_f32 v155, v155, v57, v58
    v_max3_f32 v154, v154, v59, v60
    v_min3_f32 v155, v155, v59, v60
    v_max3_f32 v154, v154, v61, v62
    v_min3_f32 v155, v155, v61, v62
    v_max3_f32 v154, v154, v63, v64
    v_min3_f32 v155, v155, v63, v64
    v_max3_f32 v154, v154, v65, v66
    v_min3_f32 v155, v155, v65, v66
    v_max_f32 v154, v154, v67
    v_min_f32 v155, v155, v67
    v_mul_f32 v156, s44, v154
    v_mul_f32 v158, s44, v155
    v_mov_b32 v157, v156
    v_mov_b32 v159, v158
    v_pk_fma_f32 v[164:165], v[48:49], s[44:45], v[158:159] neg_lo:[1,0,0] neg_hi:[1,0,0]
    v_pk_fma_f32 v[48:49], v[48:49], s[44:45], v[156:157] neg_lo:[0,0,1] neg_hi:[0,0,1]
    v_pk_fma_f32 v[166:167], v[50:51], s[44:45], v[158:159] neg_lo:[1,0,0] neg_hi:[1,0,0]
    v_pk_fma_f32 v[50:51], v[50:51], s[44:45], v[156:157] neg_lo:[0,0,1] neg_hi:[0,0,1]
    v_pk_fma_f32 v[168:169], v[52:53], s[44:45], v[158:159] neg_lo:[1,0,0] neg_hi:[1,0,0]
    v_pk_fma_f32 v[52:53], v[52:53], s[44:45], v[156:157] neg_lo:[0,0,1] neg_hi:[0,0,1]
    v_pk_fma_f32 v[170:171], v[54:55], s[44:45], v[158:159] neg_lo:[1,0,0] neg_hi:[1,0,0]
    v_pk_fma_f32 v[54:55], v[54:55], s[44:45], v[156:157] neg_lo:[0,0,1] neg_hi:[0,0,1]
    v_pk_fma_f32 v[172:173], v[56:57], s[44:45], v[158:159] neg_lo:[1,0,0] neg_hi:[1,0,0]
    v_pk_fma_f32 v[56:57], v[56:57], s[44:45], v[156:157] neg_lo:[0,0,1] neg_hi:[0,0,1]
    v_pk_fma_f32 v[174:175], v[58:59], s[44:45], v[158:159] neg_lo:[1,0,0] neg_hi:[1,0,0]
    v_pk_fma_f32 v[58:59], v[58:59], s[44:45], v[156:157] neg_lo:[0,0,1] neg_hi:[0,0,1]
    v_pk_fma_f32 v[176:177], v[60:61], s[44:45], v[158:159] neg_lo:[1,0,0] neg_hi:[1,0,0]
    v_pk_fma_f32 v[60:61], v[60:61], s[44:45], v[156:157] neg_lo:[0,0,1] neg_hi:[0,0,1]
    v_pk_fma_f32 v[178:179], v[62:63], s[44:45], v[158:159] neg_lo:[1,0,0] neg_hi:[1,0,0]
    v_pk_fma_f32 v[62:63], v[62:63], s[44:45], v[156:157] neg_lo:[0,0,1] neg_hi:[0,0,1]
    v_pk_fma_f32 v[180:181], v[64:65], s[44:45], v[158:159] neg_lo:[1,0,0] neg_hi:[1,0,0]
    v_pk_fma_f32 v[64:65], v[64:65], s[44:45], v[156:157] neg_lo:[0,0,1] neg_hi:[0,0,1]
    v_pk_fma_f32 v[182:183], v[66:67], s[44:45], v[158:159] neg_lo:[1,0,0] neg_hi:[1,0,0]
    v_pk_fma_f32 v[66:67], v[66:67], s[44:45], v[156:157] neg_lo:[0,0,1] neg_hi:[0,0,1]
    v_exp_f32 v164, v164
    v_exp_f32 v48, v48
    v_exp_f32 v165, v165
    v_exp_f32 v49, v49
    v_exp_f32 v166, v166
    v_exp_f32 v50, v50
    v_exp_f32 v167, v167
    v_exp_f32 v51, v51
    v_exp_f32 v168, v168
    v_exp_f32 v52, v52
    v_exp_f32 v169, v169
    v_exp_f32 v53, v53
    v_exp_f32 v170, v170
    v_exp_f32 v54, v54
    buffer_load_dwordx4 v[252:255], v2, s[20:23], s67 offen offset:1024
    v_exp_f32 v171, v171
    v_exp_f32 v55, v55
    v_exp_f32 v172, v172
    v_exp_f32 v56, v56
    v_exp_f32 v173, v173
    v_exp_f32 v57, v57
    v_exp_f32 v174, v174
    v_exp_f32 v58, v58
    v_exp_f32 v175, v175
    v_exp_f32 v59, v59
    v_exp_f32 v176, v176
    v_exp_f32 v60, v60
    v_exp_f32 v177, v177
    v_exp_f32 v61, v61
    buffer_load_dwordx4 v[252:255], v2, s[20:23], s67 offen offset:1536
    v_exp_f32 v178, v178
    v_exp_f32 v62, v62
    v_exp_f32 v179, v179
    v_exp_f32 v63, v63
    v_exp_f32 v180, v180
    v_exp_f32 v64, v64
    v_exp_f32 v181, v181
    v_exp_f32 v65, v65
    v_exp_f32 v182, v182
    v_exp_f32 v66, v66
    v_exp_f32 v183, v183
    v_exp_f32 v67, v67
    s_nop 0
    v_pk_add_f32 v[158:159], v[164:165], v[166:167]
    v_pk_add_f32 v[156:157], v[48:49], v[50:51]
    v_pk_add_f32 v[158:159], v[158:159], v[168:169]
    v_pk_add_f32 v[156:157], v[156:157], v[52:53]
    v_pk_add_f32 v[158:159], v[158:159], v[170:171]
    v_pk_add_f32 v[156:157], v[156:157], v[54:55]
    v_pk_add_f32 v[158:159], v[158:159], v[172:173]
    v_pk_add_f32 v[156:157], v[156:157], v[56:57]
    v_pk_add_f32 v[158:159], v[158:159], v[174:175]
    v_pk_add_f32 v[156:157], v[156:157], v[58:59]
    v_pk_add_f32 v[158:159], v[158:159], v[176:177]
    v_pk_add_f32 v[156:157], v[156:157], v[60:61]
    v_pk_add_f32 v[158:159], v[158:159], v[178:179]
    v_pk_add_f32 v[156:157], v[156:157], v[62:63]
    v_pk_add_f32 v[158:159], v[158:159], v[180:181]
    v_pk_add_f32 v[156:157], v[156:157], v[64:65]
    v_pk_add_f32 v[158:159], v[158:159], v[182:183]
    v_pk_add_f32 v[156:157], v[156:157], v[66:67]
    v_add_f32 v158, v158, v159
    v_add_f32 v156, v156, v157
    v_rcp_f32 v158, v158
    v_rcp_f32 v156, v156
    s_nop 0
    v_mov_b32 v159, v158
    v_mov_b32 v157, v156
    v_pk_mul_f32 v[48:49], v[48:49], v[156:157]
    v_pk_mul_f32 v[164:165], v[164:165], v[158:159]
    v_pk_mul_f32 v[50:51], v[50:51], v[156:157]
    v_pk_mul_f32 v[166:167], v[166:167], v[158:159]
    v_pk_mul_f32 v[52:53], v[52:53], v[156:157]
    v_pk_mul_f32 v[168:169], v[168:169], v[158:159]
    v_pk_mul_f32 v[54:55], v[54:55], v[156:157]
    v_pk_mul_f32 v[170:171], v[170:171], v[158:159]
    v_pk_mul_f32 v[56:57], v[56:57], v[156:157]
    v_pk_mul_f32 v[172:173], v[172:173], v[158:159]
    v_pk_mul_f32 v[58:59], v[58:59], v[156:157]
    v_pk_mul_f32 v[174:175], v[174:175], v[158:159]
    v_pk_mul_f32 v[60:61], v[60:61], v[156:157]
    v_pk_mul_f32 v[176:177], v[176:177], v[158:159]
    v_pk_mul_f32 v[62:63], v[62:63], v[156:157]
    v_pk_mul_f32 v[178:179], v[178:179], v[158:159]
    v_pk_mul_f32 v[64:65], v[64:65], v[156:157]
    v_pk_mul_f32 v[180:181], v[180:181], v[158:159]
    v_pk_mul_f32 v[66:67], v[66:67], v[156:157]
    v_pk_mul_f32 v[182:183], v[182:183], v[158:159]
    v_cvt_pk_bf16_f32 v184, v48, v49
    v_cvt_pk_bf16_f32 v185, v50, v51
    v_cvt_pk_bf16_f32 v186, v52, v53
    v_cvt_pk_bf16_f32 v187, v54, v55
    v_cvt_pk_bf16_f32 v188, v56, v57
    v_cvt_pk_bf16_f32 v189, v58, v59
    v_cvt_pk_bf16_f32 v190, v60, v61
    v_cvt_pk_bf16_f32 v191, v62, v63
    v_cvt_pk_bf16_f32 v192, v64, v65
    v_cvt_pk_bf16_f32 v193, v66, v67
    v_cvt_pk_bf16_f32 v194, v164, v165
    v_cvt_pk_bf16_f32 v195, v166, v167
    v_cvt_pk_bf16_f32 v196, v168, v169
    v_cvt_pk_bf16_f32 v197, v170, v171
    v_cvt_pk_bf16_f32 v198, v172, v173
    v_cvt_pk_bf16_f32 v199, v174, v175
    v_cvt_pk_bf16_f32 v200, v176, v177
    v_cvt_pk_bf16_f32 v201, v178, v179
    v_cvt_pk_bf16_f32 v202, v180, v181
    v_cvt_pk_bf16_f32 v203, v182, v183
    s_mov_b32 exec_lo, 0
    ds_write_b128 v101, v[184:187] offset:0
    ds_write_b128 v101, v[188:191] offset:16
    ds_write_b128 v101, v[192:195] offset:32
    ds_write_b128 v101, v[196:199] offset:48
    ds_write_b128 v101, v[200:203] offset:64
    s_mov_b32 exec_lo, -1
    s_mov_b32 exec_hi, 0
    buffer_store_dwordx4 v[184:187], v7, s[8:11], s39 offen offset:0
    buffer_store_dwordx4 v[188:191], v7, s[8:11], s39 offen offset:256
    buffer_store_dwordx4 v[192:195], v7, s[8:11], s39 offen offset:512
    buffer_store_dwordx4 v[196:199], v7, s[8:11], s39 offen offset:768
    buffer_store_dwordx4 v[200:203], v7, s[8:11], s39 offen offset:1024
    s_mov_b64 exec, -1
    s_nop 1
    s_waitcnt lgkmcnt(0)
    s_barrier
    s_lshr_b32 s40, s37, 1
    s_and_b32 s41, s37, 1
    v_lshrrev_b32 v10, 2, v1
    v_mul_u32_u24 v10, 288, v10
    v_add_u32 v10, 0, v10
    v_and_b32 v11, 3, v1
    v_lshlrev_b32 v12, 3, v11
    s_mul_i32 s42, s40, 80
    v_add3_u32 v13, v10, v12, s42
    s_mul_i32 s42, s40, 40
    s_add_u32 s42, s42, 160
    v_add_u32 v14, s42, v12
    s_add_u32 s43, s42, 32
    v_mov_b32 v15, 240
    v_mov_b32 v9, s43
    v_cmp_eq_u32 vcc, 0, v11
    s_nop 1
    v_cndmask_b32 v15, v15, v9, vcc
    s_cmp_eq_u32 s41, 0
    s_cselect_b64 vcc, -1, 0
    s_nop 1
    v_cndmask_b32 v14, v15, v14, vcc
    v_add_u32 v14, v14, v10
    ds_read_b64_tr_b16 v[80:81], v14 offset:0
    ds_read_b64_tr_b16 v[82:83], v14 offset:4608
    ds_read_b64_tr_b16 v[84:85], v13 offset:0
    ds_read_b64_tr_b16 v[86:87], v13 offset:4608
    ds_read_b64_tr_b16 v[88:89], v13 offset:32
    ds_read_b64_tr_b16 v[90:91], v13 offset:4640
    ds_read_b64_tr_b16 v[92:93], v13 offset:64
    ds_read_b64_tr_b16 v[94:95], v13 offset:4672
    ds_read_b64_tr_b16 v[112:113], v14 offset:9216
    ds_read_b64_tr_b16 v[114:115], v14 offset:13824
    ds_read_b64_tr_b16 v[116:117], v13 offset:9216
    ds_read_b64_tr_b16 v[118:119], v13 offset:13824
    ds_read_b64_tr_b16 v[120:121], v13 offset:9248
    ds_read_b64_tr_b16 v[122:123], v13 offset:13856
    ds_read_b64_tr_b16 v[124:125], v13 offset:9280
    ds_read_b64_tr_b16 v[126:127], v13 offset:13888
    s_waitcnt lgkmcnt(8)
    v_mfma_f32_16x16x32_bf16 v[16:19], v[80:83], v[84:87], 0
    v_mfma_f32_16x16x32_bf16 v[20:23], v[80:83], v[88:91], 0
    v_mfma_f32_16x16x32_bf16 v[24:27], v[80:83], v[92:95], 0
    ds_read_b64_tr_b16 v[80:81], v14 offset:18432
    ds_read_b64_tr_b16 v[82:83], v14 offset:23040
    ds_read_b64_tr_b16 v[84:85], v13 offset:18432
    ds_read_b64_tr_b16 v[86:87], v13 offset:23040
    ds_read_b64_tr_b16 v[88:89], v13 offset:18464
    ds_read_b64_tr_b16 v[90:91], v13 offset:23072
    ds_read_b64_tr_b16 v[92:93], v13 offset:18496
    ds_read_b64_tr_b16 v[94:95], v13 offset:23104
    s_waitcnt lgkmcnt(8)
    v_mfma_f32_16x16x32_bf16 v[16:19], v[112:115], v[116:119], v[16:19]
    v_mfma_f32_16x16x32_bf16 v[20:23], v[112:115], v[120:123], v[20:23]
    v_mfma_f32_16x16x32_bf16 v[24:27], v[112:115], v[124:127], v[24:27]
    ds_read_b64_tr_b16 v[112:113], v14 offset:27648
    ds_read_b64_tr_b16 v[114:115], v14 offset:32256
    ds_read_b64_tr_b16 v[116:117], v13 offset:27648
    ds_read_b64_tr_b16 v[118:119], v13 offset:32256
    ds_read_b64_tr_b16 v[120:121], v13 offset:27680
    ds_read_b64_tr_b16 v[122:123], v13 offset:32288
    ds_read_b64_tr_b16 v[124:125], v13 offset:27712
    ds_read_b64_tr_b16 v[126:127], v13 offset:32320
    s_waitcnt lgkmcnt(8)
    v_mfma_f32_16x16x32_bf16 v[16:19], v[80:83], v[84:87], v[16:19]
    v_mfma_f32_16x16x32_bf16 v[20:23], v[80:83], v[88:91], v[20:23]
    v_mfma_f32_16x16x32_bf16 v[24:27], v[80:83], v[92:95], v[24:27]
    s_waitcnt lgkmcnt(0)
    v_mfma_f32_16x16x32_bf16 v[16:19], v[112:115], v[116:119], v[16:19]
    v_mfma_f32_16x16x32_bf16 v[20:23], v[112:115], v[120:123], v[20:23]
    v_mfma_f32_16x16x32_bf16 v[24:27], v[112:115], v[124:127], v[24:27]
    v_lshrrev_b32 v10, 4, v1
    v_mul_u32_u24 v10, 640, v10
    v_and_b32 v11, 15, v1
    v_lshlrev_b32 v11, 2, v11
    v_add_u32 v10, v10, v11
    s_mul_i32 s42, s40, 3360
    s_mul_i32 s43, s41, 2560
    s_add_u32 s42, s42, s43
    s_add_u32 s42, s42, 40960
    v_add_u32 v10, s42, v10
    s_cmp_eq_u32 s41, 0
    s_cselect_b32 s46, -1, -1
    s_cselect_b32 s47, -1, 0
    s_cselect_b32 s38, -1, 0xffff
    s_cselect_b32 s39, -1, 0
    s_mov_b32 s64, 0x00ff00ff
    s_mov_b32 s65, 0x00ff00ff
    s_nop 4
    s_mov_b32 exec_lo, s46
    s_mov_b32 exec_hi, s47
    ds_write_b32 v10, v16 offset:0
    s_mov_b32 exec_lo, s38
    s_mov_b32 exec_hi, s39
    ds_write_b32 v10, v17 offset:160
    s_mov_b32 exec_lo, s38
    s_mov_b32 exec_hi, s39
    ds_write_b32 v10, v18 offset:320
    s_mov_b32 exec_lo, s38
    s_mov_b32 exec_hi, s39
    ds_write_b32 v10, v19 offset:480
    s_mov_b32 exec_lo, s46
    s_mov_b32 exec_hi, s47
    ds_write_b32 v10, v20 offset:64
    s_mov_b32 exec_lo, s38
    s_mov_b32 exec_hi, s39
    ds_write_b32 v10, v21 offset:224
    s_mov_b32 exec_lo, s38
    s_mov_b32 exec_hi, s39
    ds_write_b32 v10, v22 offset:384
    s_mov_b32 exec_lo, s38
    s_mov_b32 exec_hi, s39
    ds_write_b32 v10, v23 offset:544
    s_and_b32 exec_lo, s46, s64
    s_and_b32 exec_hi, s47, s65
    ds_write_b32 v10, v24 offset:128
    s_and_b32 exec_lo, s38, s64
    s_and_b32 exec_hi, s39, s65
    ds_write_b32 v10, v25 offset:288
    s_and_b32 exec_lo, s38, s64
    s_and_b32 exec_hi, s39, s65
    ds_write_b32 v10, v26 offset:448
    s_and_b32 exec_lo, s38, s64
    s_and_b32 exec_hi, s39, s65
    ds_write_b32 v10, v27 offset:608
    s_mov_b64 exec, -1
    s_waitcnt lgkmcnt(0)
    s_barrier
    v_lshlrev_b32 v10, 2, v0
    v_add_u32 v11, 40960, v10
    ds_read_b32 v16, v11 offset:0
    ds_read_b32 v17, v11 offset:1024
    ds_read_b32 v18, v11 offset:2048
    ds_read_b32 v19, v11 offset:3072
    ds_read_b32 v20, v11 offset:4096
    ds_read_b32 v21, v11 offset:5120
    ds_read_b32 v22, v11 offset:6144
    s_mul_i32 s42, s33, 6720
    s_waitcnt lgkmcnt(0)
    s_add_u32 s43, s42, 0
    buffer_atomic_add_f32 v16, v10, s[8:11], s43 offen
    s_add_u32 s43, s42, 1024
    buffer_atomic_add_f32 v17, v10, s[8:11], s43 offen
    s_add_u32 s43, s42, 2048
    buffer_atomic_add_f32 v18, v10, s[8:11], s43 offen
    s_add_u32 s43, s42, 3072
    buffer_atomic_add_f32 v19, v10, s[8:11], s43 offen
    s_add_u32 s43, s42, 4096
    buffer_atomic_add_f32 v20, v10, s[8:11], s43 offen
    s_add_u32 s43, s42, 5120
    buffer_atomic_add_f32 v21, v10, s[8:11], s43 offen
    s_add_u32 s43, s42, 6144
    v_cmp_gt_u32 vcc, 144, v0
    s_and_saveexec_b64 s[64:65], vcc
    s_cbranch_execz K1_AT_DONE
    buffer_atomic_add_f32 v22, v10, s[8:11], s43 offen
K1_AT_DONE:
    s_mov_b64 exec, s[64:65]
    s_cmp_lg_u32 s2, 0
    s_cbranch_scc1 K1_NOKEY
    s_cmp_lg_u32 s37, 3
    s_cbranch_scc1 K1_NOKEY
    v_lshlrev_b32 v14, 5, v1
    s_mov_b32 s64, 163840
    buffer_load_dwordx4 v[136:139], v14, s[8:11], s64 offen
    buffer_load_dwordx4 v[140:143], v14, s[8:11], s64 offen offset:16
    s_waitcnt vmcnt(0)
    v_max_u32 v136, v136, v137
    v_max_u32 v138, v138, v139
    v_max_u32 v140, v140, v141
    v_max_u32 v142, v142, v143
    v_max_u32 v136, v136, v138
    v_max_u32 v140, v140, v142
    v_max_u32 v136, v136, v140
    s_nop 1
    v_max_u32_dpp v136, v136, v136 row_ror:1 row_mask:0xf bank_mask:0xf
    s_nop 1
    v_max_u32_dpp v136, v136, v136 row_ror:2 row_mask:0xf bank_mask:0xf
    s_nop 1
    v_max_u32_dpp v136, v136, v136 row_ror:4 row_mask:0xf bank_mask:0xf
    s_nop 1
    v_max_u32_dpp v136, v136, v136 row_ror:8 row_mask:0xf bank_mask:0xf
    v_mov_b32 v137, v136
    s_nop 1
    v_permlane16_swap_b32 v136, v137
    s_nop 1
    v_max_u32 v136, v136, v137
    v_mov_b32 v137, v136
    s_nop 1
    v_permlane32_swap_b32 v136, v137
    s_nop 1
    v_max_u32 v136, v136, v137
    v_mov_b32 v14, 0
    s_mov_b32 s64, 167936
    s_mov_b64 exec, 1
    buffer_store_dword v136, v14, s[8:11], s64 offen
    s_mov_b64 exec, -1
K1_NOKEY:
K1_END:
    s_endpgm
.globl k2_kernel
.p2align 8
.type k2_kernel,@function
k2_kernel:

    s_cmp_ge_u32 s2, 208
    s_cbranch_scc1 K2_END
    s_load_dwordx2 s[48:49], s[0:1], 0
    s_load_dwordx4 s[52:55], s[0:1], 48
    s_load_dwordx4 s[56:59], s[0:1], 64
    s_load_dwordx4 s[60:63], s[0:1], 80
    v_and_b32 v1, 63, v0
    v_lshrrev_b32 v10, 6, v0
    s_nop 0
    v_readfirstlane_b32 s32, v10
    s_waitcnt lgkmcnt(0)
    s_mov_b32 s4, s48
    s_mov_b32 s5, s49
    s_mov_b32 s6, 2621440
    s_mov_b32 s7, 0x20000
    s_mov_b32 s20, s52
    s_mov_b32 s21, s53
    s_mov_b32 s22, 1966080
    s_mov_b32 s23, 0x20000
    s_mov_b32 s24, s54
    s_mov_b32 s25, s55
    s_mov_b32 s26, 1966080
    s_mov_b32 s27, 0x20000
    s_mov_b32 s28, s56
    s_mov_b32 s29, s57
    s_mov_b32 s30, 1966080
    s_mov_b32 s31, 0x20000
    s_mov_b32 s16, s58
    s_mov_b32 s17, s59
    s_mov_b32 s18, 2621440
    s_mov_b32 s19, 0x20000
    s_mov_b32 s12, s60
    s_mov_b32 s13, s61
    s_mov_b32 s14, 256
    s_mov_b32 s15, 0x20000
    s_mov_b32 s8, s62
    s_mov_b32 s9, s63
    s_mov_b32 s10, 268435456
    s_mov_b32 s11, 0x20000
    s_add_u32 s64, s62, 167936
    s_addc_u32 s65, s63, 0
    s_load_dword s80, s[64:65], 0
    s_cmp_lt_u32 s2, 48
    s_cbranch_scc1 K2_AUX
    s_sub_u32 s38, s2, 48
    s_and_b32 s39, s38, 7
    s_lshr_b32 s40, s38, 3
    s_and_b32 s41, s40, 3
    s_lshl_b32 s39, s39, 2
    s_add_u32 s33, s39, s41
    s_lshr_b32 s34, s40, 2
    v_and_b32 v10, 31, v1
    v_lshrrev_b32 v11, 3, v10
    v_lshlrev_b32 v11, 2, v11
    v_and_b32 v12, 3, v10
    v_add_u32 v11, v11, v12
    v_bfe_u32 v12, v10, 2, 1
    v_mul_u32_u24 v12, 10, v12
    v_add_u32 v12, v12, v11
    v_mov_b32 v13, 20
    v_cmp_gt_u32 vcc, 10, v11
    s_nop 1
    v_cndmask_b32 v12, v13, v12, vcc
    v_mul_u32_u24 v12, 160, v12
    v_lshrrev_b32 v13, 5, v1
    v_lshlrev_b32 v14, 5, v13
    v_add_u32 v2, v12, v14
    v_mov_b32 v3, v12
    v_bfe_u32 v11, v10, 4, 1
    v_mul_u32_u24 v11, 40960, v11
    v_lshlrev_b32 v14, 8, v13
    v_and_b32 v15, 15, v10
    v_lshlrev_b32 v15, 4, v15
    v_add3_u32 v4, v11, v14, v15
    s_lshl_b32 s42, s32, 2
    s_mul_i32 s43, s42, 3360
    s_lshl_b32 s44, s33, 2
    s_lshl_b32 s44, s44, 5
    s_add_u32 s44, s44, s42
    s_mul_i32 s44, s44, 1280
    s_add_u32 s44, s44, 2097152
    s_and_b32 s45, s32, 3
    s_lshr_b32 s46, s32, 2
    s_lshl_b32 s47, s34, 2
    s_add_u32 s47, s47, s45
    s_mul_i32 s47, s47, 40
    s_mul_i32 s66, s46, 20
    s_add_u32 s47, s47, s66
    s_lshl_b32 s47, s47, 10
    s_add_u32 s47, s47, 1048576
    v_lshlrev_b32 v5, 4, v1
    s_add_u32 s66, s43, 0
    v_lshlrev_b32 v9, 4, v1
    s_mov_b32 m0, s43
    buffer_load_dwordx4 v9, s[8:11], s66 offen lds
    s_add_u32 m0, m0, 1024
    s_add_u32 s66, s66, 1024
    buffer_load_dwordx4 v9, s[8:11], s66 offen lds
    s_add_u32 m0, m0, 1024
    s_add_u32 s66, s66, 1024
    buffer_load_dwordx4 v9, s[8:11], s66 offen lds
    s_add_u32 m0, m0, 1024
    s_add_u32 s66, s66, 1024
    buffer_load_dwordx4 v9, s[8:11], s66 offen lds
    s_add_u32 m0, m0, 1024
    s_add_u32 s66, s66, 1024
    buffer_load_dwordx4 v9, s[8:11], s66 offen lds
    s_add_u32 m0, m0, 1024
    s_add_u32 s66, s66, 1024
    buffer_load_dwordx4 v9, s[8:11], s66 offen lds
    s_add_u32 m0, m0, 1024
    s_add_u32 s66, s66, 1024
    buffer_load_dwordx4 v9, s[8:11], s66 offen lds
    s_add_u32 m0, m0, 1024
    s_add_u32 s66, s66, 1024
    buffer_load_dwordx4 v9, s[8:11], s66 offen lds
    s_add_u32 m0, m0, 1024
    s_add_u32 s66, s66, 1024
    buffer_load_dwordx4 v9, s[8:11], s66 offen lds
    s_add_u32 m0, m0, 1024
    s_add_u32 s66, s66, 1024
    buffer_load_dwordx4 v9, s[8:11], s66 offen lds
    s_add_u32 m0, m0, 1024
    s_add_u32 s66, s66, 1024
    buffer_load_dwordx4 v9, s[8:11], s66 offen lds
    s_add_u32 m0, m0, 1024
    s_add_u32 s66, s66, 1024
    buffer_load_dwordx4 v9, s[8:11], s66 offen lds
    s_add_u32 m0, m0, 1024
    s_add_u32 s66, s66, 1024
    buffer_load_dwordx4 v9, s[8:11], s66 offen lds
    s_add_u32 m0, m0, 1024
    s_add_u32 s66, s66, 1024
    s_mov_b64 exec, 0xff
    buffer_load_dwordx4 v9, s[8:11], s66 offen lds
    s_mov_b64 exec, -1
    s_add_u32 s66, s44, 0
    s_add_u32 s67, s66, 81920
    buffer_load_dwordx4 v[74:77], v4, s[8:11], s66 offen offset:0
    buffer_load_dwordx4 v[78:81], v4, s[8:11], s66 offen offset:512
    v_mov_b32 v82, 0
    v_mov_b32 v83, 0
    v_mov_b32 v84, 0
    v_mov_b32 v85, 0
    s_mov_b32 exec_hi, 0
    buffer_load_dwordx4 v[82:85], v4, s[8:11], s66 offen offset:1024
    s_mov_b32 exec_hi, -1
    buffer_load_dwordx4 v[86:89], v4, s[8:11], s67 offen offset:0
    buffer_load_dwordx4 v[90:93], v4, s[8:11], s67 offen offset:512
    v_mov_b32 v94, 0
    v_mov_b32 v95, 0
    v_mov_b32 v96, 0
    v_mov_b32 v97, 0
    s_mov_b32 exec_hi, 0
    buffer_load_dwordx4 v[94:97], v4, s[8:11], s67 offen offset:1024
    s_mov_b32 exec_hi, -1
    s_add_u32 s66, s44, 1280
    s_add_u32 s67, s66, 81920
    buffer_load_dwordx4 v[98:101], v4, s[8:11], s66 offen offset:0
    buffer_load_dwordx4 v[102:105], v4, s[8:11], s66 offen offset:512
    v_mov_b32 v106, 0
    v_mov_b32 v107, 0
    v_mov_b32 v108, 0
    v_mov_b32 v109, 0
    s_mov_b32 exec_hi, 0
    buffer_load_dwordx4 v[106:109], v4, s[8:11], s66 offen offset:1024
    s_mov_b32 exec_hi, -1
    buffer_load_dwordx4 v[110:113], v4, s[8:11], s67 offen offset:0
    buffer_load_dwordx4 v[114:117], v4, s[8:11], s67 offen offset:512
    v_mov_b32 v118, 0
    v_mov_b32 v119, 0
    v_mov_b32 v120, 0
    v_mov_b32 v121, 0
    s_mov_b32 exec_hi, 0
    buffer_load_dwordx4 v[118:121], v4, s[8:11], s67 offen offset:1024
    s_mov_b32 exec_hi, -1
    s_barrier
    s_add_u32 s67, s47, 0
    buffer_load_dwordx4 v[122:125], v5, s[8:11], s67 offen offset:0
    s_add_u32 s67, s47, 0
    buffer_load_dwordx4 v[126:129], v5, s[8:11], s67 offen offset:1024
    s_add_u32 s67, s47, 0
    buffer_load_dwordx4 v[130:133], v5, s[8:11], s67 offen offset:2048
    s_add_u32 s67, s47, 0
    buffer_load_dwordx4 v[134:137], v5, s[8:11], s67 offen offset:3072
    s_add_u32 s67, s47, 4096
    buffer_load_dwordx4 v[138:141], v5, s[8:11], s67 offen offset:0
    s_mul_i32 s66, s32, 10240
    v_lshlrev_b32 v6, 4, v1
    v_add_u32 v6, s66, v6
    s_mov_b32 s68, 0x358637bd
    v_add_u32 v2, s43, v2
    v_add_u32 v3, s43, v3
    s_waitcnt vmcnt(17)
    ds_read_b128 v[202:205], v2 offset:0
    ds_read_b128 v[206:209], v2 offset:16
    ds_read_b128 v[210:213], v2 offset:64
    ds_read_b128 v[214:217], v2 offset:80
    ds_read_b128 v[218:221], v3 offset:128
    ds_read_b128 v[222:225], v3 offset:144
    s_waitcnt lgkmcnt(0)
    v_cvt_pk_bf16_f32 v26, v202, v203
    v_cvt_pk_bf16_f32 v27, v204, v205
    v_cvt_pk_bf16_f32 v28, v206, v207
    v_cvt_pk_bf16_f32 v29, v208, v209
    v_cvt_pk_bf16_f32 v30, v210, v211
    v_cvt_pk_bf16_f32 v31, v212, v213
    v_cvt_pk_bf16_f32 v32, v214, v215
    v_cvt_pk_bf16_f32 v33, v216, v217
    v_cvt_pk_bf16_f32 v34, v218, v219
    v_cvt_pk_bf16_f32 v35, v220, v221
    v_cvt_pk_bf16_f32 v36, v222, v223
    v_cvt_pk_bf16_f32 v37, v224, v225
    ds_read_b128 v[202:205], v2 offset:3360
    ds_read_b128 v[206:209], v2 offset:3376
    ds_read_b128 v[210:213], v2 offset:3424
    ds_read_b128 v[214:217], v2 offset:3440
    ds_read_b128 v[218:221], v3 offset:3488
    ds_read_b128 v[222:225], v3 offset:3504
    s_waitcnt lgkmcnt(0)
    v_cvt_pk_bf16_f32 v38, v202, v203
    v_cvt_pk_bf16_f32 v39, v204, v205
    v_cvt_pk_bf16_f32 v40, v206, v207
    v_cvt_pk_bf16_f32 v41, v208, v209
    v_cvt_pk_bf16_f32 v42, v210, v211
    v_cvt_pk_bf16_f32 v43, v212, v213
    v_cvt_pk_bf16_f32 v44, v214, v215
    v_cvt_pk_bf16_f32 v45, v216, v217
    v_cvt_pk_bf16_f32 v46, v218, v219
    v_cvt_pk_bf16_f32 v47, v220, v221
    v_cvt_pk_bf16_f32 v48, v222, v223
    v_cvt_pk_bf16_f32 v49, v224, v225
    ds_read_b128 v[202:205], v2 offset:6720
    ds_read_b128 v[206:209], v2 offset:6736
    ds_read_b128 v[210:213], v2 offset:6784
    ds_read_b128 v[214:217], v2 offset:6800
    ds_read_b128 v[218:221], v3 offset:6848
    ds_read_b128 v[222:225], v3 offset:6864
    s_waitcnt lgkmcnt(0)
    v_cvt_pk_bf16_f32 v50, v202, v203
    v_cvt_pk_bf16_f32 v51, v204, v205
    v_cvt_pk_bf16_f32 v52, v206, v207
    v_cvt_pk_bf16_f32 v53, v208, v209
    v_cvt_pk_bf16_f32 v54, v210, v211
    v_cvt_pk_bf16_f32 v55, v212, v213
    v_cvt_pk_bf16_f32 v56, v214, v215
    v_cvt_pk_bf16_f32 v57, v216, v217
    v_cvt_pk_bf16_f32 v58, v218, v219
    v_cvt_pk_bf16_f32 v59, v220, v221
    v_cvt_pk_bf16_f32 v60, v222, v223
    v_cvt_pk_bf16_f32 v61, v224, v225
    ds_read_b128 v[202:205], v2 offset:10080
    ds_read_b128 v[206:209], v2 offset:10096
    ds_read_b128 v[210:213], v2 offset:10144
    ds_read_b128 v[214:217], v2 offset:10160
    ds_read_b128 v[218:221], v3 offset:10208
    ds_read_b128 v[222:225], v3 offset:10224
    s_waitcnt lgkmcnt(0)
    v_cvt_pk_bf16_f32 v62, v202, v203
    v_cvt_pk_bf16_f32 v63, v204, v205
    v_cvt_pk_bf16_f32 v64, v206, v207
    v_cvt_pk_bf16_f32 v65, v208, v209
    v_cvt_pk_bf16_f32 v66, v210, v211
    v_cvt_pk_bf16_f32 v67, v212, v213
    v_cvt_pk_bf16_f32 v68, v214, v215
    v_cvt_pk_bf16_f32 v69, v216, v217
    v_cvt_pk_bf16_f32 v70, v218, v219
    v_cvt_pk_bf16_f32 v71, v220, v221
    v_cvt_pk_bf16_f32 v72, v222, v223
    v_cvt_pk_bf16_f32 v73, v224, v225
    s_barrier
    s_waitcnt vmcnt(11)
    v_mfma_f32_32x32x16_bf16 v[202:217], v[26:29], v[74:77], 0
    v_mfma_f32_32x32x16_bf16 v[202:217], v[30:33], v[78:81], v[202:217]
    v_mfma_f32_32x32x16_bf16 v[202:217], v[34:37], v[82:85], v[202:217]
    v_mfma_f32_32x32x16_bf16 v[218:233], v[26:29], v[86:89], 0
    v_mfma_f32_32x32x16_bf16 v[218:233], v[30:33], v[90:93], v[218:233]
    v_mfma_f32_32x32x16_bf16 v[218:233], v[34:37], v[94:97], v[218:233]
    s_add_u32 s66, s44, 2560
    s_add_u32 s67, s66, 81920
    buffer_load_dwordx4 v[74:77], v4, s[8:11], s66 offen offset:0
    buffer_load_dwordx4 v[78:81], v4, s[8:11], s66 offen offset:512
    v_mov_b32 v82, 0
    v_mov_b32 v83, 0
    v_mov_b32 v84, 0
    v_mov_b32 v85, 0
    s_mov_b32 exec_hi, 0
    buffer_load_dwordx4 v[82:85], v4, s[8:11], s66 offen offset:1024
    s_mov_b32 exec_hi, -1
    buffer_load_dwordx4 v[86:89], v4, s[8:11], s67 offen offset:0
    buffer_load_dwordx4 v[90:93], v4, s[8:11], s67 offen offset:512
    v_mov_b32 v94, 0
    v_mov_b32 v95, 0
    v_mov_b32 v96, 0
    v_mov_b32 v97, 0
    s_mov_b32 exec_hi, 0
    buffer_load_dwordx4 v[94:97], v4, s[8:11], s67 offen offset:1024
    s_mov_b32 exec_hi, -1
    s_nop 7
    s_nop 3
    v_cvt_pk_bf16_f32 v10, v212, v212
    v_and_b32 v10, 0xffff0000, v10
    v_add_f32 v10, s68, v10
    v_cvt_pk_bf16_f32 v10, v10, v10
    v_and_b32 v10, 0xffff0000, v10
    v_rcp_f32 v10, v10
    v_cvt_pk_bf16_f32 v16, v202, v203
    v_cvt_pk_bf16_f32 v17, v204, v205
    v_cvt_pk_bf16_f32 v18, v206, v207
    v_cvt_pk_bf16_f32 v19, v208, v209
    v_cvt_pk_bf16_f32 v20, v210, v211
    v_mov_b32 v11, v10
    v_lshlrev_b32 v202, 16, v16
    v_and_b32 v203, 0xffff0000, v16
    v_lshlrev_b32 v204, 16, v17
    v_and_b32 v205, 0xffff0000, v17
    v_lshlrev_b32 v206, 16, v18
    v_and_b32 v207, 0xffff0000, v18
    v_lshlrev_b32 v208, 16, v19
    v_and_b32 v209, 0xffff0000, v19
    v_lshlrev_b32 v210, 16, v20
    v_and_b32 v211, 0xffff0000, v20
    v_pk_mul_f32 v[202:203], v[202:203], v[10:11]
    v_pk_mul_f32 v[204:205], v[204:205], v[10:11]
    v_pk_mul_f32 v[206:207], v[206:207], v[10:11]
    v_pk_mul_f32 v[208:209], v[208:209], v[10:11]
    v_pk_mul_f32 v[210:211], v[210:211], v[10:11]
    v_cvt_pk_bf16_f32 v21, v202, v203
    v_cvt_pk_bf16_f32 v22, v204, v205
    v_cvt_pk_bf16_f32 v23, v206, v207
    v_cvt_pk_bf16_f32 v24, v208, v209
    v_cvt_pk_bf16_f32 v25, v210, v211
    ds_write_b32 v6, v21 offset:0
    ds_write_b32 v6, v22 offset:4
    ds_write_b32 v6, v23 offset:8
    ds_write_b32 v6, v24 offset:12
    ds_write_b32 v6, v25 offset:2048
    v_cvt_pk_bf16_f32 v10, v228, v228
    v_and_b32 v10, 0xffff0000, v10
    v_add_f32 v10, s68, v10
    v_cvt_pk_bf16_f32 v10, v10, v10
    v_and_b32 v10, 0xffff0000, v10
    v_rcp_f32 v10, v10
    v_cvt_pk_bf16_f32 v16, v218, v219
    v_cvt_pk_bf16_f32 v17, v220, v221
    v_cvt_pk_bf16_f32 v18, v222, v223
    v_cvt_pk_bf16_f32 v19, v224, v225
    v_cvt_pk_bf16_f32 v20, v226, v227
    v_mov_b32 v11, v10
    v_lshlrev_b32 v218, 16, v16
    v_and_b32 v219, 0xffff0000, v16
    v_lshlrev_b32 v220, 16, v17
    v_and_b32 v221, 0xffff0000, v17
    v_lshlrev_b32 v222, 16, v18
    v_and_b32 v223, 0xffff0000, v18
    v_lshlrev_b32 v224, 16, v19
    v_and_b32 v225, 0xffff0000, v19
    v_lshlrev_b32 v226, 16, v20
    v_and_b32 v227, 0xffff0000, v20
    v_pk_mul_f32 v[218:219], v[218:219], v[10:11]
    v_pk_mul_f32 v[220:221], v[220:221], v[10:11]
    v_pk_mul_f32 v[222:223], v[222:223], v[10:11]
    v_pk_mul_f32 v[224:225], v[224:225], v[10:11]
    v_pk_mul_f32 v[226:227], v[226:227], v[10:11]
    v_cvt_pk_bf16_f32 v21, v218, v219
    v_cvt_pk_bf16_f32 v22, v220, v221
    v_cvt_pk_bf16_f32 v23, v222, v223
    v_cvt_pk_bf16_f32 v24, v224, v225
    v_cvt_pk_bf16_f32 v25, v226, v227
    ds_write_b32 v6, v21 offset:1024
    ds_write_b32 v6, v22 offset:1028
    ds_write_b32 v6, v23 offset:1032
    ds_write_b32 v6, v24 offset:1036
    ds_write_b32 v6, v25 offset:3072
    s_waitcnt vmcnt(11)
    v_mfma_f32_32x32x16_bf16 v[202:217], v[38:41], v[98:101], 0
    v_mfma_f32_32x32x16_bf16 v[202:217], v[42:45], v[102:105], v[202:217]
    v_mfma_f32_32x32x16_bf16 v[202:217], v[46:49], v[106:109], v[202:217]
    v_mfma_f32_32x32x16_bf16 v[218:233], v[38:41], v[110:113], 0
    v_mfma_f32_32x32x16_bf16 v[218:233], v[42:45], v[114:117], v[218:233]
    v_mfma_f32_32x32x16_bf16 v[218:233], v[46:49], v[118:121], v[218:233]
    s_add_u32 s66, s44, 3840
    s_add_u32 s67, s66, 81920
    buffer_load_dwordx4 v[98:101], v4, s[8:11], s66 offen offset:0
    buffer_load_dwordx4 v[102:105], v4, s[8:11], s66 offen offset:512
    v_mov_b32 v106, 0
    v_mov_b32 v107, 0
    v_mov_b32 v108, 0
    v_mov_b32 v109, 0
    s_mov_b32 exec_hi, 0
    buffer_load_dwordx4 v[106:109], v4, s[8:11], s66 offen offset:1024
    s_mov_b32 exec_hi, -1
    buffer_load_dwordx4 v[110:113], v4, s[8:11], s67 offen offset:0
    buffer_load_dwordx4 v[114:117], v4, s[8:11], s67 offen offset:512
    v_mov_b32 v118, 0
    v_mov_b32 v119, 0
    v_mov_b32 v120, 0
    v_mov_b32 v121, 0
    s_mov_b32 exec_hi, 0
    buffer_load_dwordx4 v[118:121], v4, s[8:11], s67 offen offset:1024
    s_mov_b32 exec_hi, -1
    s_nop 7
    s_nop 3
    v_cvt_pk_bf16_f32 v10, v212, v212
    v_and_b32 v10, 0xffff0000, v10
    v_add_f32 v10, s68, v10
    v_cvt_pk_bf16_f32 v10, v10, v10
    v_and_b32 v10, 0xffff0000, v10
    v_rcp_f32 v10, v10
    v_cvt_pk_bf16_f32 v16, v202, v203
    v_cvt_pk_bf16_f32 v17, v204, v205
    v_cvt_pk_bf16_f32 v18, v206, v207
    v_cvt_pk_bf16_f32 v19, v208, v209
    v_cvt_pk_bf16_f32 v20, v210, v211
    v_mov_b32 v11, v10
    v_lshlrev_b32 v202, 16, v16
    v_and_b32 v203, 0xffff0000, v16
    v_lshlrev_b32 v204, 16, v17
    v_and_b32 v205, 0xffff0000, v17
    v_lshlrev_b32 v206, 16, v18
    v_and_b32 v207, 0xffff0000, v18
    v_lshlrev_b32 v208, 16, v19
    v_and_b32 v209, 0xffff0000, v19
    v_lshlrev_b32 v210, 16, v20
    v_and_b32 v211, 0xffff0000, v20
    v_pk_mul_f32 v[202:203], v[202:203], v[10:11]
    v_pk_mul_f32 v[204:205], v[204:205], v[10:11]
    v_pk_mul_f32 v[206:207], v[206:207], v[10:11]
    v_pk_mul_f32 v[208:209], v[208:209], v[10:11]
    v_pk_mul_f32 v[210:211], v[210:211], v[10:11]
    v_cvt_pk_bf16_f32 v21, v202, v203
    v_cvt_pk_bf16_f32 v22, v204, v205
    v_cvt_pk_bf16_f32 v23, v206, v207
    v_cvt_pk_bf16_f32 v24, v208, v209
    v_cvt_pk_bf16_f32 v25, v210, v211
    ds_write_b32 v6, v21 offset:2052
    ds_write_b32 v6, v22 offset:2056
    ds_write_b32 v6, v23 offset:2060
    ds_write_b32 v6, v24 offset:4096
    ds_write_b32 v6, v25 offset:4100
    v_cvt_pk_bf16_f32 v10, v228, v228
    v_and_b32 v10, 0xffff0000, v10
    v_add_f32 v10, s68, v10
    v_cvt_pk_bf16_f32 v10, v10, v10
    v_and_b32 v10, 0xffff0000, v10
    v_rcp_f32 v10, v10
    v_cvt_pk_bf16_f32 v16, v218, v219
    v_cvt_pk_bf16_f32 v17, v220, v221
    v_cvt_pk_bf16_f32 v18, v222, v223
    v_cvt_pk_bf16_f32 v19, v224, v225
    v_cvt_pk_bf16_f32 v20, v226, v227
    v_mov_b32 v11, v10
    v_lshlrev_b32 v218, 16, v16
    v_and_b32 v219, 0xffff0000, v16
    v_lshlrev_b32 v220, 16, v17
    v_and_b32 v221, 0xffff0000, v17
    v_lshlrev_b32 v222, 16, v18
    v_and_b32 v223, 0xffff0000, v18
    v_lshlrev_b32 v224, 16, v19
    v_and_b32 v225, 0xffff0000, v19
    v_lshlrev_b32 v226, 16, v20
    v_and_b32 v227, 0xffff0000, v20
    v_pk_mul_f32 v[218:219], v[218:219], v[10:11]
    v_pk_mul_f32 v[220:221], v[220:221], v[10:11]
    v_pk_mul_f32 v[222:223], v[222:223], v[10:11]
    v_pk_mul_f32 v[224:225], v[224:225], v[10:11]
    v_pk_mul_f32 v[226:227], v[226:227], v[10:11]
    v_cvt_pk_bf16_f32 v21, v218, v219
    v_cvt_pk_bf16_f32 v22, v220, v221
    v_cvt_pk_bf16_f32 v23, v222, v223
    v_cvt_pk_bf16_f32 v24, v224, v225
    v_cvt_pk_bf16_f32 v25, v226, v227
    ds_write_b32 v6, v21 offset:3076
    ds_write_b32 v6, v22 offset:3080
    ds_write_b32 v6, v23 offset:3084
    ds_write_b32 v6, v24 offset:5120
    ds_write_b32 v6, v25 offset:5124
    s_waitcnt vmcnt(6)
    v_mfma_f32_32x32x16_bf16 v[202:217], v[50:53], v[74:77], 0
    v_mfma_f32_32x32x16_bf16 v[202:217], v[54:57], v[78:81], v[202:217]
    v_mfma_f32_32x32x16_bf16 v[202:217], v[58:61], v[82:85], v[202:217]
    v_mfma_f32_32x32x16_bf16 v[218:233], v[50:53], v[86:89], 0
    v_mfma_f32_32x32x16_bf16 v[218:233], v[54:57], v[90:93], v[218:233]
    v_mfma_f32_32x32x16_bf16 v[218:233], v[58:61], v[94:97], v[218:233]
    s_add_u32 s67, s47, 4096
    buffer_load_dwordx4 v[142:145], v5, s[8:11], s67 offen offset:1024
    s_add_u32 s67, s47, 4096
    buffer_load_dwordx4 v[146:149], v5, s[8:11], s67 offen offset:2048
    s_add_u32 s67, s47, 4096
    buffer_load_dwordx4 v[150:153], v5, s[8:11], s67 offen offset:3072
    s_add_u32 s67, s47, 8192
    buffer_load_dwordx4 v[154:157], v5, s[8:11], s67 offen offset:0
    s_add_u32 s67, s47, 8192
    buffer_load_dwordx4 v[158:161], v5, s[8:11], s67 offen offset:1024
    s_add_u32 s67, s47, 8192
    buffer_load_dwordx4 v[162:165], v5, s[8:11], s67 offen offset:2048
    s_add_u32 s67, s47, 8192
    buffer_load_dwordx4 v[166:169], v5, s[8:11], s67 offen offset:3072
    s_add_u32 s67, s47, 12288
    buffer_load_dwordx4 v[170:173], v5, s[8:11], s67 offen offset:0
    s_nop 7
    s_nop 3
    v_cvt_pk_bf16_f32 v10, v212, v212
    v_and_b32 v10, 0xffff0000, v10
    v_add_f32 v10, s68, v10
    v_cvt_pk_bf16_f32 v10, v10, v10
    v_and_b32 v10, 0xffff0000, v10
    v_rcp_f32 v10, v10
    v_cvt_pk_bf16_f32 v16, v202, v203
    v_cvt_pk_bf16_f32 v17, v204, v205
    v_cvt_pk_bf16_f32 v18, v206, v207
    v_cvt_pk_bf16_f32 v19, v208, v209
    v_cvt_pk_bf16_f32 v20, v210, v211
    v_mov_b32 v11, v10
    v_lshlrev_b32 v202, 16, v16
    v_and_b32 v203, 0xffff0000, v16
    v_lshlrev_b32 v204, 16, v17
    v_and_b32 v205, 0xffff0000, v17
    v_lshlrev_b32 v206, 16, v18
    v_and_b32 v207, 0xffff0000, v18
    v_lshlrev_b32 v208, 16, v19
    v_and_b32 v209, 0xffff0000, v19
    v_lshlrev_b32 v210, 16, v20
    v_and_b32 v211, 0xffff0000, v20
    v_pk_mul_f32 v[202:203], v[202:203], v[10:11]
    v_pk_mul_f32 v[204:205], v[204:205], v[10:11]
    v_pk_mul_f32 v[206:207], v[206:207], v[10:11]
    v_pk_mul_f32 v[208:209], v[208:209], v[10:11]
    v_pk_mul_f32 v[210:211], v[210:211], v[10:11]
    v_cvt_pk_bf16_f32 v21, v202, v203
    v_cvt_pk_bf16_f32 v22, v204, v205
    v_cvt_pk_bf16_f32 v23, v206, v207
    v_cvt_pk_bf16_f32 v24, v208, v209
    v_cvt_pk_bf16_f32 v25, v210, v211
    ds_write_b32 v6, v21 offset:4104
    ds_write_b32 v6, v22 offset:4108
    ds_write_b32 v6, v23 offset:6144
    ds_write_b32 v6, v24 offset:6148
    ds_write_b32 v6, v25 offset:6152
    v_cvt_pk_bf16_f32 v10, v228, v228
    v_and_b32 v10, 0xffff0000, v10
    v_add_f32 v10, s68, v10
    v_cvt_pk_bf16_f32 v10, v10, v10
    v_and_b32 v10, 0xffff0000, v10
    v_rcp_f32 v10, v10
    v_cvt_pk_bf16_f32 v16, v218, v219
    v_cvt_pk_bf16_f32 v17, v220, v221
    v_cvt_pk_bf16_f32 v18, v222, v223
    v_cvt_pk_bf16_f32 v19, v224, v225
    v_cvt_pk_bf16_f32 v20, v226, v227
    v_mov_b32 v11, v10
    v_lshlrev_b32 v218, 16, v16
    v_and_b32 v219, 0xffff0000, v16
    v_lshlrev_b32 v220, 16, v17
    v_and_b32 v221, 0xffff0000, v17
    v_lshlrev_b32 v222, 16, v18
    v_and_b32 v223, 0xffff0000, v18
    v_lshlrev_b32 v224, 16, v19
    v_and_b32 v225, 0xffff0000, v19
    v_lshlrev_b32 v226, 16, v20
    v_and_b32 v227, 0xffff0000, v20
    v_pk_mul_f32 v[218:219], v[218:219], v[10:11]
    v_pk_mul_f32 v[220:221], v[220:221], v[10:11]
    v_pk_mul_f32 v[222:223], v[222:223], v[10:11]
    v_pk_mul_f32 v[224:225], v[224:225], v[10:11]
    v_pk_mul_f32 v[226:227], v[226:227], v[10:11]
    v_cvt_pk_bf16_f32 v21, v218, v219
    v_cvt_pk_bf16_f32 v22, v220, v221
    v_cvt_pk_bf16_f32 v23, v222, v223
    v_cvt_pk_bf16_f32 v24, v224, v225
    v_cvt_pk_bf16_f32 v25, v226, v227
    ds_write_b32 v6, v21 offset:5128
    ds_write_b32 v6, v22 offset:5132
    ds_write_b32 v6, v23 offset:7168
    ds_write_b32 v6, v24 offset:7172
    ds_write_b32 v6, v25 offset:7176
    s_waitcnt vmcnt(8)
    v_mfma_f32_32x32x16_bf16 v[202:217], v[62:65], v[98:101], 0
    v_mfma_f32_32x32x16_bf16 v[202:217], v[66:69], v[102:105], v[202:217]
    v_mfma_f32_32x32x16_bf16 v[202:217], v[70:73], v[106:109], v[202:217]
    v_mfma_f32_32x32x16_bf16 v[218:233], v[62:65], v[110:113], 0
    v_mfma_f32_32x32x16_bf16 v[218:233], v[66:69], v[114:117], v[218:233]
    v_mfma_f32_32x32x16_bf16 v[218:233], v[70:73], v[118:121], v[218:233]
    s_add_u32 s67, s47, 12288
    buffer_load_dwordx4 v[174:177], v5, s[8:11], s67 offen offset:1024
    s_add_u32 s67, s47, 12288
    buffer_load_dwordx4 v[178:181], v5, s[8:11], s67 offen offset:2048
    s_add_u32 s67, s47, 12288
    buffer_load_dwordx4 v[182:185], v5, s[8:11], s67 offen offset:3072
    s_add_u32 s67, s47, 16384
    buffer_load_dwordx4 v[186:189], v5, s[8:11], s67 offen offset:0
    s_add_u32 s67, s47, 16384
    buffer_load_dwordx4 v[190:193], v5, s[8:11], s67 offen offset:1024
    s_add_u32 s67, s47, 16384
    buffer_load_dwordx4 v[194:197], v5, s[8:11], s67 offen offset:2048
    s_add_u32 s67, s47, 16384
    buffer_load_dwordx4 v[198:201], v5, s[8:11], s67 offen offset:3072
    s_nop 7
    s_nop 3
    v_cvt_pk_bf16_f32 v10, v212, v212
    v_and_b32 v10, 0xffff0000, v10
    v_add_f32 v10, s68, v10
    v_cvt_pk_bf16_f32 v10, v10, v10
    v_and_b32 v10, 0xffff0000, v10
    v_rcp_f32 v10, v10
    v_cvt_pk_bf16_f32 v16, v202, v203
    v_cvt_pk_bf16_f32 v17, v204, v205
    v_cvt_pk_bf16_f32 v18, v206, v207
    v_cvt_pk_bf16_f32 v19, v208, v209
    v_cvt_pk_bf16_f32 v20, v210, v211
    v_mov_b32 v11, v10
    v_lshlrev_b32 v202, 16, v16
    v_and_b32 v203, 0xffff0000, v16
    v_lshlrev_b32 v204, 16, v17
    v_and_b32 v205, 0xffff0000, v17
    v_lshlrev_b32 v206, 16, v18
    v_and_b32 v207, 0xffff0000, v18
    v_lshlrev_b32 v208, 16, v19
    v_and_b32 v209, 0xffff0000, v19
    v_lshlrev_b32 v210, 16, v20
    v_and_b32 v211, 0xffff0000, v20
    v_pk_mul_f32 v[202:203], v[202:203], v[10:11]
    v_pk_mul_f32 v[204:205], v[204:205], v[10:11]
    v_pk_mul_f32 v[206:207], v[206:207], v[10:11]
    v_pk_mul_f32 v[208:209], v[208:209], v[10:11]
    v_pk_mul_f32 v[210:211], v[210:211], v[10:11]
    v_cvt_pk_bf16_f32 v21, v202, v203
    v_cvt_pk_bf16_f32 v22, v204, v205
    v_cvt_pk_bf16_f32 v23, v206, v207
    v_cvt_pk_bf16_f32 v24, v208, v209
    v_cvt_pk_bf16_f32 v25, v210, v211
    ds_write_b32 v6, v21 offset:6156
    ds_write_b32 v6, v22 offset:8192
    ds_write_b32 v6, v23 offset:8196
    ds_write_b32 v6, v24 offset:8200
    ds_write_b32 v6, v25 offset:8204
    v_cvt_pk_bf16_f32 v10, v228, v228
    v_and_b32 v10, 0xffff0000, v10
    v_add_f32 v10, s68, v10
    v_cvt_pk_bf16_f32 v10, v10, v10
    v_and_b32 v10, 0xffff0000, v10
    v_rcp_f32 v10, v10
    v_cvt_pk_bf16_f32 v16, v218, v219
    v_cvt_pk_bf16_f32 v17, v220, v221
    v_cvt_pk_bf16_f32 v18, v222, v223
    v_cvt_pk_bf16_f32 v19, v224, v225
    v_cvt_pk_bf16_f32 v20, v226, v227
    v_mov_b32 v11, v10
    v_lshlrev_b32 v218, 16, v16
    v_and_b32 v219, 0xffff0000, v16
    v_lshlrev_b32 v220, 16, v17
    v_and_b32 v221, 0xffff0000, v17
    v_lshlrev_b32 v222, 16, v18
    v_and_b32 v223, 0xffff0000, v18
    v_lshlrev_b32 v224, 16, v19
    v_and_b32 v225, 0xffff0000, v19
    v_lshlrev_b32 v226, 16, v20
    v_and_b32 v227, 0xffff0000, v20
    v_pk_mul_f32 v[218:219], v[218:219], v[10:11]
    v_pk_mul_f32 v[220:221], v[220:221], v[10:11]
    v_pk_mul_f32 v[222:223], v[222:223], v[10:11]
    v_pk_mul_f32 v[224:225], v[224:225], v[10:11]
    v_pk_mul_f32 v[226:227], v[226:227], v[10:11]
    v_cvt_pk_bf16_f32 v21, v218, v219
    v_cvt_pk_bf16_f32 v22, v220, v221
    v_cvt_pk_bf16_f32 v23, v222, v223
    v_cvt_pk_bf16_f32 v24, v224, v225
    v_cvt_pk_bf16_f32 v25, v226, v227
    ds_write_b32 v6, v21 offset:7180
    ds_write_b32 v6, v22 offset:9216
    ds_write_b32 v6, v23 offset:9220
    ds_write_b32 v6, v24 offset:9224
    ds_write_b32 v6, v25 offset:9228
    s_lshl_b32 s66, s33, 6
    s_lshl_b32 s67, s46, 5
    s_add_u32 s66, s66, s67
    v_and_b32 v10, 31, v1
    v_add_u32 v10, s66, v10
    v_lshlrev_b32 v11, 3, v10
    s_mov_b32 s67, 131072
    buffer_load_dwordx2 v[34:35], v11, s[8:11], s67 offen
    s_movk_i32 s67, 1280
    v_mul_lo_u32 v7, v10, s67
    s_lshl_b32 s67, s34, 8
    s_lshl_b32 s69, s45, 6
    s_add_u32 s67, s67, s69
    v_lshrrev_b32 v11, 5, v1
    v_lshlrev_b32 v11, 5, v11
    v_add3_u32 v7, v7, v11, s67
    buffer_load_dwordx4 v[26:29], v7, s[4:7], 0 offen
    buffer_load_dwordx4 v[30:33], v7, s[4:7], 0 offen offset:16
    v_mov_b32 v8, v10
    s_waitcnt vmcnt(10) lgkmcnt(0)
    s_barrier
    s_mul_i32 s66, s46, 40960
    v_lshlrev_b32 v6, 4, v1
    v_add_u32 v6, s66, v6
    s_waitcnt lgkmcnt(0)
    s_mov_b32 s36, s80
    s_and_b32 s81, s80, 0x7ff
    s_sub_u32 s35, 2047, s81
    s_lshl_b32 s66, s33, 6
    s_lshl_b32 s67, s46, 5
    s_add_u32 s66, s66, s67
    s_sub_u32 s67, s35, s66
    s_cmp_lt_u32 s67, 32
    s_cselect_b32 s71, 1, 0
    s_cmp_eq_u32 s71, 0
    s_cbranch_scc1 K2_NOOWN_E
    v_mov_b32 v10, 0
K2_POLL:
    buffer_load_dword v11, v10, s[12:15], 0 offen sc0 sc1
    s_waitcnt vmcnt(0)
    s_nop 0
    v_readfirstlane_b32 s69, v11
    s_nop 3
    s_cmp_ge_u32 s69, 48
    s_cbranch_scc1 K2_POLLED
    s_sleep 2
    s_branch K2_POLL
K2_POLLED:
    v_and_b32 v10, 31, v1
    v_lshlrev_b32 v10, 2, v10
    v_lshrrev_b32 v11, 5, v1
    v_mul_u32_u24 v11, 61440, v11
    v_add_u32 v10, v10, v11
    s_lshl_b32 s69, s34, 9
    s_lshl_b32 s70, s45, 7
    s_add_u32 s69, s69, s70
    s_add_u32 s69, s69, 196608
    s_add_u32 s70, s69, 0
    buffer_load_dword v80, v10, s[8:11], s70 offen sc0 sc1
    s_add_u32 s70, s69, 2560
    buffer_load_dword v81, v10, s[8:11], s70 offen sc0 sc1
    s_add_u32 s70, s69, 5120
    buffer_load_dword v82, v10, s[8:11], s70 offen sc0 sc1
    s_add_u32 s70, s69, 7680
    buffer_load_dword v83, v10, s[8:11], s70 offen sc0 sc1
    s_add_u32 s70, s69, 10240
    buffer_load_dword v84, v10, s[8:11], s70 offen sc0 sc1
    s_add_u32 s70, s69, 12800
    buffer_load_dword v85, v10, s[8:11], s70 offen sc0 sc1
    s_add_u32 s70, s69, 15360
    buffer_load_dword v86, v10, s[8:11], s70 offen sc0 sc1
    s_add_u32 s70, s69, 17920
    buffer_load_dword v87, v10, s[8:11], s70 offen sc0 sc1
    s_add_u32 s70, s69, 20480
    buffer_load_dword v88, v10, s[8:11], s70 offen sc0 sc1
    s_add_u32 s70, s69, 23040
    buffer_load_dword v89, v10, s[8:11], s70 offen sc0 sc1
    s_add_u32 s70, s69, 25600
    buffer_load_dword v90, v10, s[8:11], s70 offen sc0 sc1
    s_add_u32 s70, s69, 28160
    buffer_load_dword v91, v10, s[8:11], s70 offen sc0 sc1
    s_add_u32 s70, s69, 30720
    buffer_load_dword v92, v10, s[8:11], s70 offen sc0 sc1
    s_add_u32 s70, s69, 33280
    buffer_load_dword v93, v10, s[8:11], s70 offen sc0 sc1
    s_add_u32 s70, s69, 35840
    buffer_load_dword v94, v10, s[8:11], s70 offen sc0 sc1
    s_add_u32 s70, s69, 38400
    buffer_load_dword v95, v10, s[8:11], s70 offen sc0 sc1
    s_add_u32 s70, s69, 40960
    buffer_load_dword v96, v10, s[8:11], s70 offen sc0 sc1
    s_add_u32 s70, s69, 43520
    buffer_load_dword v97, v10, s[8:11], s70 offen sc0 sc1
    s_add_u32 s70, s69, 46080
    buffer_load_dword v98, v10, s[8:11], s70 offen sc0 sc1
    s_add_u32 s70, s69, 48640
    buffer_load_dword v99, v10, s[8:11], s70 offen sc0 sc1
    s_add_u32 s70, s69, 51200
    buffer_load_dword v100, v10, s[8:11], s70 offen sc0 sc1
    s_add_u32 s70, s69, 53760
    buffer_load_dword v101, v10, s[8:11], s70 offen sc0 sc1
    s_add_u32 s70, s69, 56320
    buffer_load_dword v102, v10, s[8:11], s70 offen sc0 sc1
    s_add_u32 s70, s69, 58880
    buffer_load_dword v103, v10, s[8:11], s70 offen sc0 sc1
K2_NOOWN_E:
    ds_read_b128 v[36:39], v6 offset:0
    ds_read_b128 v[40:43], v6 offset:1024
    ds_read_b128 v[44:47], v6 offset:2048
    ds_read_b128 v[48:51], v6 offset:3072
    s_waitcnt lgkmcnt(2)
    v_mfma_f32_32x32x16_bf16 v[202:217], v[122:125], v[36:39], 0
    v_mfma_f32_32x32x16_bf16 v[218:233], v[122:125], v[40:43], 0
    ds_read_b128 v[36:39], v6 offset:4096
    ds_read_b128 v[40:43], v6 offset:5120
    s_waitcnt lgkmcnt(2)
    v_mfma_f32_32x32x16_bf16 v[202:217], v[126:129], v[44:47], v[202:217]
    v_mfma_f32_32x32x16_bf16 v[218:233], v[126:129], v[48:51], v[218:233]
    ds_read_b128 v[44:47], v6 offset:6144
    ds_read_b128 v[48:51], v6 offset:7168
    s_waitcnt lgkmcnt(2)
    v_mfma_f32_32x32x16_bf16 v[202:217], v[130:133], v[36:39], v[202:217]
    v_mfma_f32_32x32x16_bf16 v[218:233], v[130:133], v[40:43], v[218:233]
    ds_read_b128 v[36:39], v6 offset:8192
    ds_read_b128 v[40:43], v6 offset:9216
    s_waitcnt lgkmcnt(2)
    v_mfma_f32_32x32x16_bf16 v[202:217], v[134:137], v[44:47], v[202:217]
    v_mfma_f32_32x32x16_bf16 v[218:233], v[134:137], v[48:51], v[218:233]
    ds_read_b128 v[44:47], v6 offset:10240
    ds_read_b128 v[48:51], v6 offset:11264
    s_waitcnt lgkmcnt(2)
    v_mfma_f32_32x32x16_bf16 v[202:217], v[138:141], v[36:39], v[202:217]
    v_mfma_f32_32x32x16_bf16 v[218:233], v[138:141], v[40:43], v[218:233]
    ds_read_b128 v[36:39], v6 offset:12288
    ds_read_b128 v[40:43], v6 offset:13312
    s_waitcnt lgkmcnt(2)
    v_mfma_f32_32x32x16_bf16 v[202:217], v[142:145], v[44:47], v[202:217]
    v_mfma_f32_32x32x16_bf16 v[218:233], v[142:145], v[48:51], v[218:233]
    ds_read_b128 v[44:47], v6 offset:14336
    ds_read_b128 v[48:51], v6 offset:15360
    s_waitcnt lgkmcnt(2)
    v_mfma_f32_32x32x16_bf16 v[202:217], v[146:149], v[36:39], v[202:217]
    v_mfma_f32_32x32x16_bf16 v[218:233], v[146:149], v[40:43], v[218:233]
    ds_read_b128 v[36:39], v6 offset:16384
    ds_read_b128 v[40:43], v6 offset:17408
    s_waitcnt lgkmcnt(2)
    v_mfma_f32_32x32x16_bf16 v[202:217], v[150:153], v[44:47], v[202:217]
    v_mfma_f32_32x32x16_bf16 v[218:233], v[150:153], v[48:51], v[218:233]
    ds_read_b128 v[44:47], v6 offset:18432
    ds_read_b128 v[48:51], v6 offset:19456
    s_waitcnt lgkmcnt(2)
    v_mfma_f32_32x32x16_bf16 v[202:217], v[154:157], v[36:39], v[202:217]
    v_mfma_f32_32x32x16_bf16 v[218:233], v[154:157], v[40:43], v[218:233]
    ds_read_b128 v[36:39], v6 offset:20480
    ds_read_b128 v[40:43], v6 offset:21504
    s_waitcnt lgkmcnt(2)
    v_mfma_f32_32x32x16_bf16 v[202:217], v[158:161], v[44:47], v[202:217]
    v_mfma_f32_32x32x16_bf16 v[218:233], v[158:161], v[48:51], v[218:233]
    ds_read_b128 v[44:47], v6 offset:22528
    ds_read_b128 v[48:51], v6 offset:23552
    s_waitcnt lgkmcnt(2)
    v_mfma_f32_32x32x16_bf16 v[202:217], v[162:165], v[36:39], v[202:217]
    v_mfma_f32_32x32x16_bf16 v[218:233], v[162:165], v[40:43], v[218:233]
    ds_read_b128 v[36:39], v6 offset:24576
    ds_read_b128 v[40:43], v6 offset:25600
    s_waitcnt lgkmcnt(2)
    v_mfma_f32_32x32x16_bf16 v[202:217], v[166:169], v[44:47], v[202:217]
    v_mfma_f32_32x32x16_bf16 v[218:233], v[166:169], v[48:51], v[218:233]
    ds_read_b128 v[44:47], v6 offset:26624
    ds_read_b128 v[48:51], v6 offset:27648
    s_waitcnt lgkmcnt(2)
    v_mfma_f32_32x32x16_bf16 v[202:217], v[170:173], v[36:39], v[202:217]
    v_mfma_f32_32x32x16_bf16 v[218:233], v[170:173], v[40:43], v[218:233]
    s_waitcnt vmcnt(3)
    ds_read_b128 v[36:39], v6 offset:28672
    ds_read_b128 v[40:43], v6 offset:29696
    s_waitcnt lgkmcnt(2)
    v_mfma_f32_32x32x16_bf16 v[202:217], v[174:177], v[44:47], v[202:217]
    v_mfma_f32_32x32x16_bf16 v[218:233], v[174:177], v[48:51], v[218:233]
    ds_read_b128 v[44:47], v6 offset:30720
    ds_read_b128 v[48:51], v6 offset:31744
    s_waitcnt lgkmcnt(2)
    v_mfma_f32_32x32x16_bf16 v[202:217], v[178:181], v[36:39], v[202:217]
    v_mfma_f32_32x32x16_bf16 v[218:233], v[178:181], v[40:43], v[218:233]
    ds_read_b128 v[36:39], v6 offset:32768
    ds_read_b128 v[40:43], v6 offset:33792
    s_waitcnt lgkmcnt(2)
    v_mfma_f32_32x32x16_bf16 v[202:217], v[182:185], v[44:47], v[202:217]
    v_mfma_f32_32x32x16_bf16 v[218:233], v[182:185], v[48:51], v[218:233]
    ds_read_b128 v[44:47], v6 offset:34816
    ds_read_b128 v[48:51], v6 offset:35840
    s_waitcnt lgkmcnt(2)
    v_mfma_f32_32x32x16_bf16 v[202:217], v[186:189], v[36:39], v[202:217]
    v_mfma_f32_32x32x16_bf16 v[218:233], v[186:189], v[40:43], v[218:233]
    ds_read_b128 v[36:39], v6 offset:36864
    ds_read_b128 v[40:43], v6 offset:37888
    s_waitcnt lgkmcnt(2)
    v_mfma_f32_32x32x16_bf16 v[202:217], v[190:193], v[44:47], v[202:217]
    v_mfma_f32_32x32x16_bf16 v[218:233], v[190:193], v[48:51], v[218:233]
    ds_read_b128 v[44:47], v6 offset:38912
    ds_read_b128 v[48:51], v6 offset:39936
    s_waitcnt lgkmcnt(2)
    v_mfma_f32_32x32x16_bf16 v[202:217], v[194:197], v[36:39], v[202:217]
    v_mfma_f32_32x32x16_bf16 v[218:233], v[194:197], v[40:43], v[218:233]
    s_waitcnt lgkmcnt(0)
    v_mfma_f32_32x32x16_bf16 v[202:217], v[198:201], v[44:47], v[202:217]
    v_mfma_f32_32x32x16_bf16 v[218:233], v[198:201], v[48:51], v[218:233]
    s_nop 7
    s_nop 3
    s_lshl_b32 s66, s32, 12
    s_add_u32 s66, s66, 81920
    v_lshlrev_b32 v6, 4, v1
    v_add_u32 v6, s66, v6
    s_xor_b32 s67, s32, 4
    s_lshl_b32 s67, s67, 12
    s_add_u32 s67, s67, 81920
    v_lshlrev_b32 v9, 4, v1
    v_add_u32 v9, s67, v9
    s_cmp_eq_u32 s46, 0
    s_cbranch_scc0 K2_ETA1
    ds_write_b128 v6, v[218:221] offset:0
    ds_write_b128 v6, v[222:225] offset:1024
    ds_write_b128 v6, v[226:229] offset:2048
    ds_write_b128 v6, v[230:233] offset:3072
    s_branch K2_ETA_J
K2_ETA1:
    ds_write_b128 v6, v[202:205] offset:0
    ds_write_b128 v6, v[206:209] offset:1024
    ds_write_b128 v6, v[210:213] offset:2048
    ds_write_b128 v6, v[214:217] offset:3072
    v_mov_b32 v202, v218
    v_mov_b32 v203, v219
    v_mov_b32 v204, v220
    v_mov_b32 v205, v221
    v_mov_b32 v206, v222
    v_mov_b32 v207, v223
    v_mov_b32 v208, v224
    v_mov_b32 v209, v225
    v_mov_b32 v210, v226
    v_mov_b32 v211, v227
    v_mov_b32 v212, v228
    v_mov_b32 v213, v229
    v_mov_b32 v214, v230
    v_mov_b32 v215, v231
    v_mov_b32 v216, v232
    v_mov_b32 v217, v233
K2_ETA_J:
    s_waitcnt lgkmcnt(0)
    s_barrier
    ds_read_b128 v[52:55], v9 offset:0
    ds_read_b128 v[56:59], v9 offset:1024
    ds_read_b128 v[60:63], v9 offset:2048
    ds_read_b128 v[64:67], v9 offset:3072
    s_waitcnt lgkmcnt(0)
    v_add_f32 v202, v202, v52
    v_add_f32 v203, v203, v53
    v_add_f32 v204, v204, v54
    v_add_f32 v205, v205, v55
    v_add_f32 v206, v206, v56
    v_add_f32 v207, v207, v57
    v_add_f32 v208, v208, v58
    v_add_f32 v209, v209, v59
    v_add_f32 v210, v210, v60
    v_add_f32 v211, v211, v61
    v_add_f32 v212, v212, v62
    v_add_f32 v213, v213, v63
    v_add_f32 v214, v214, v64
    v_add_f32 v215, v215, v65
    v_add_f32 v216, v216, v66
    v_add_f32 v217, v217, v67
    v_mov_b32 v120, 0
    v_mov_b32 v121, 0
    v_mov_b32 v122, 0
    v_mov_b32 v123, 0
    v_mov_b32 v124, 0
    v_mov_b32 v125, 0
    v_mov_b32 v126, 0
    v_mov_b32 v127, 0
    v_mov_b32 v128, 0
    v_mov_b32 v129, 0
    v_mov_b32 v130, 0
    v_mov_b32 v131, 0
    v_mov_b32 v132, 0
    v_mov_b32 v133, 0
    v_mov_b32 v134, 0
    v_mov_b32 v135, 0
    s_cmp_eq_u32 s71, 0
    s_cbranch_scc1 K2_NOOWN
    s_waitcnt vmcnt(0)
    v_add_f32 v80, v80, v81
    v_add_f32 v80, v80, v82
    v_add_f32 v80, v80, v83
    v_add_f32 v80, v80, v84
    v_add_f32 v80, v80, v85
    v_add_f32 v80, v80, v86
    v_add_f32 v80, v80, v87
    v_add_f32 v80, v80, v88
    v_add_f32 v80, v80, v89
    v_add_f32 v80, v80, v90
    v_add_f32 v80, v80, v91
    v_add_f32 v80, v80, v92
    v_add_f32 v80, v80, v93
    v_add_f32 v80, v80, v94
    v_add_f32 v80, v80, v95
    v_add_f32 v80, v80, v96
    v_add_f32 v80, v80, v97
    v_add_f32 v80, v80, v98
    v_add_f32 v80, v80, v99
    v_add_f32 v80, v80, v100
    v_add_f32 v80, v80, v101
    v_add_f32 v80, v80, v102
    v_add_f32 v80, v80, v103
    v_mov_b32 v81, v80
    s_nop 1
    v_permlane32_swap_b32 v80, v81
    s_nop 1
    v_add_f32 v80, v80, v81
    v_cvt_pk_bf16_f32 v80, v80, v80
    v_and_b32 v80, 0xffff0000, v80
    s_and_b32 s69, s36, 0xffff0000
    s_xor_b32 s70, s69, 0x80000000
    s_not_b32 s71, s69
    s_and_b32 s71, s71, 0xffff0000
    s_cmp_lt_i32 s69, 0
    s_cselect_b32 s69, s70, s71
    v_mov_b32 v81, s69
    v_mul_f32 v81, 0xbfb8aa3b, v81
    v_exp_f32 v81, v81
    s_nop 0
    v_add_f32 v81, 1.0, v81
    v_rcp_f32 v81, v81
    s_nop 0
    v_cvt_pk_bf16_f32 v81, v81, v81
    v_and_b32 v81, 0xffff0000, v81
    v_mul_f32 v80, v80, v81
    v_cvt_pk_bf16_f32 v80, v80, v80
    v_and_b32 v80, 0xffff0000, v80
    s_lshl_b32 s69, s32, 8
    v_and_b32 v10, 31, v1
    v_lshlrev_b32 v10, 2, v10
    v_add_u32 v10, s69, v10
    ds_write_b32 v10, v80
    v_lshrrev_b32 v11, 5, v1
    v_lshlrev_b32 v11, 6, v11
    v_add_u32 v11, s69, v11
    s_waitcnt lgkmcnt(0)
    ds_read_b128 v[120:123], v11
    ds_read_b128 v[124:127], v11 offset:16
    ds_read_b128 v[128:131], v11 offset:32
    ds_read_b128 v[132:135], v11 offset:48
    s_waitcnt lgkmcnt(0)
    v_cmp_eq_u32 vcc, s35, v8
    s_nop 1
    v_cndmask_b32 v120, 0, v120, vcc
    v_cndmask_b32 v121, 0, v121, vcc
    v_cndmask_b32 v122, 0, v122, vcc
    v_cndmask_b32 v123, 0, v123, vcc
    v_cndmask_b32 v124, 0, v124, vcc
    v_cndmask_b32 v125, 0, v125, vcc
    v_cndmask_b32 v126, 0, v126, vcc
    v_cndmask_b32 v127, 0, v127, vcc
    v_cndmask_b32 v128, 0, v128, vcc
    v_cndmask_b32 v129, 0, v129, vcc
    v_cndmask_b32 v130, 0, v130, vcc
    v_cndmask_b32 v131, 0, v131, vcc
    v_cndmask_b32 v132, 0, v132, vcc
    v_cndmask_b32 v133, 0, v133, vcc
    v_cndmask_b32 v134, 0, v134, vcc
    v_cndmask_b32 v135, 0, v135, vcc
K2_NOOWN:
    s_waitcnt vmcnt(0)
    v_sub_f32 v160, 0, v34
    v_lshlrev_b32 v140, 16, v26
    v_and_b32 v141, 0xffff0000, v26
    v_cvt_pk_bf16_f32 v142, v202, v203
    v_lshlrev_b32 v143, 16, v142
    v_and_b32 v144, 0xffff0000, v142
    v_add_f32 v143, v140, v143
    v_add_f32 v144, v141, v144
    v_cvt_pk_bf16_f32 v142, v143, v144
    v_lshlrev_b32 v143, 16, v142
    v_and_b32 v144, 0xffff0000, v142
    v_add_f32 v140, v140, v160
    v_add_f32 v141, v141, v160
    v_cvt_pk_bf16_f32 v145, v140, v141
    v_lshlrev_b32 v140, 16, v145
    v_and_b32 v141, 0xffff0000, v145
    v_mul_f32 v140, v140, v35
    v_mul_f32 v141, v141, v35
    v_cvt_pk_bf16_f32 v145, v140, v141
    v_lshlrev_b32 v140, 16, v145
    v_and_b32 v141, 0xffff0000, v145
    v_add_f32 v140, v140, v120
    v_add_f32 v141, v141, v121
    v_cvt_pk_bf16_f32 v145, v140, v141
    v_lshlrev_b32 v140, 16, v145
    v_and_b32 v141, 0xffff0000, v145
    v_add_f32 v140, v140, v143
    v_add_f32 v141, v141, v144
    v_cvt_pk_bf16_f32 v148, v140, v141
    v_lshlrev_b32 v140, 16, v27
    v_and_b32 v141, 0xffff0000, v27
    v_cvt_pk_bf16_f32 v142, v204, v205
    v_lshlrev_b32 v143, 16, v142
    v_and_b32 v144, 0xffff0000, v142
    v_add_f32 v143, v140, v143
    v_add_f32 v144, v141, v144
    v_cvt_pk_bf16_f32 v142, v143, v144
    v_lshlrev_b32 v143, 16, v142
    v_and_b32 v144, 0xffff0000, v142
    v_add_f32 v140, v140, v160
    v_add_f32 v141, v141, v160
    v_cvt_pk_bf16_f32 v145, v140, v141
    v_lshlrev_b32 v140, 16, v145
    v_and_b32 v141, 0xffff0000, v145
    v_mul_f32 v140, v140, v35
    v_mul_f32 v141, v141, v35
    v_cvt_pk_bf16_f32 v145, v140, v141
    v_lshlrev_b32 v140, 16, v145
    v_and_b32 v141, 0xffff0000, v145
    v_add_f32 v140, v140, v122
    v_add_f32 v141, v141, v123
    v_cvt_pk_bf16_f32 v145, v140, v141
    v_lshlrev_b32 v140, 16, v145
    v_and_b32 v141, 0xffff0000, v145
    v_add_f32 v140, v140, v143
    v_add_f32 v141, v141, v144
    v_cvt_pk_bf16_f32 v149, v140, v141
    v_lshlrev_b32 v140, 16, v28
    v_and_b32 v141, 0xffff0000, v28
    v_cvt_pk_bf16_f32 v142, v206, v207
    v_lshlrev_b32 v143, 16, v142
    v_and_b32 v144, 0xffff0000, v142
    v_add_f32 v143, v140, v143
    v_add_f32 v144, v141, v144
    v_cvt_pk_bf16_f32 v142, v143, v144
    v_lshlrev_b32 v143, 16, v142
    v_and_b32 v144, 0xffff0000, v142
    v_add_f32 v140, v140, v160
    v_add_f32 v141, v141, v160
    v_cvt_pk_bf16_f32 v145, v140, v141
    v_lshlrev_b32 v140, 16, v145
    v_and_b32 v141, 0xffff0000, v145
    v_mul_f32 v140, v140, v35
    v_mul_f32 v141, v141, v35
    v_cvt_pk_bf16_f32 v145, v140, v141
    v_lshlrev_b32 v140, 16, v145
    v_and_b32 v141, 0xffff0000, v145
    v_add_f32 v140, v140, v124
    v_add_f32 v141, v141, v125
    v_cvt_pk_bf16_f32 v145, v140, v141
    v_lshlrev_b32 v140, 16, v145
    v_and_b32 v141, 0xffff0000, v145
    v_add_f32 v140, v140, v143
    v_add_f32 v141, v141, v144
    v_cvt_pk_bf16_f32 v150, v140, v141
    v_lshlrev_b32 v140, 16, v29
    v_and_b32 v141, 0xffff0000, v29
    v_cvt_pk_bf16_f32 v142, v208, v209
    v_lshlrev_b32 v143, 16, v142
    v_and_b32 v144, 0xffff0000, v142
    v_add_f32 v143, v140, v143
    v_add_f32 v144, v141, v144
    v_cvt_pk_bf16_f32 v142, v143, v144
    v_lshlrev_b32 v143, 16, v142
    v_and_b32 v144, 0xffff0000, v142
    v_add_f32 v140, v140, v160
    v_add_f32 v141, v141, v160
    v_cvt_pk_bf16_f32 v145, v140, v141
    v_lshlrev_b32 v140, 16, v145
    v_and_b32 v141, 0xffff0000, v145
    v_mul_f32 v140, v140, v35
    v_mul_f32 v141, v141, v35
    v_cvt_pk_bf16_f32 v145, v140, v141
    v_lshlrev_b32 v140, 16, v145
    v_and_b32 v141, 0xffff0000, v145
    v_add_f32 v140, v140, v126
    v_add_f32 v141, v141, v127
    v_cvt_pk_bf16_f32 v145, v140, v141
    v_lshlrev_b32 v140, 16, v145
    v_and_b32 v141, 0xffff0000, v145
    v_add_f32 v140, v140, v143
    v_add_f32 v141, v141, v144
    v_cvt_pk_bf16_f32 v151, v140, v141
    v_lshlrev_b32 v140, 16, v30
    v_and_b32 v141, 0xffff0000, v30
    v_cvt_pk_bf16_f32 v142, v210, v211
    v_lshlrev_b32 v143, 16, v142
    v_and_b32 v144, 0xffff0000, v142
    v_add_f32 v143, v140, v143
    v_add_f32 v144, v141, v144
    v_cvt_pk_bf16_f32 v142, v143, v144
    v_lshlrev_b32 v143, 16, v142
    v_and_b32 v144, 0xffff0000, v142
    v_add_f32 v140, v140, v160
    v_add_f32 v141, v141, v160
    v_cvt_pk_bf16_f32 v145, v140, v141
    v_lshlrev_b32 v140, 16, v145
    v_and_b32 v141, 0xffff0000, v145
    v_mul_f32 v140, v140, v35
    v_mul_f32 v141, v141, v35
    v_cvt_pk_bf16_f32 v145, v140, v141
    v_lshlrev_b32 v140, 16, v145
    v_and_b32 v141, 0xffff0000, v145
    v_add_f32 v140, v140, v128
    v_add_f32 v141, v141, v129
    v_cvt_pk_bf16_f32 v145, v140, v141
    v_lshlrev_b32 v140, 16, v145
    v_and_b32 v141, 0xffff0000, v145
    v_add_f32 v140, v140, v143
    v_add_f32 v141, v141, v144
    v_cvt_pk_bf16_f32 v152, v140, v141
    v_lshlrev_b32 v140, 16, v31
    v_and_b32 v141, 0xffff0000, v31
    v_cvt_pk_bf16_f32 v142, v212, v213
    v_lshlrev_b32 v143, 16, v142
    v_and_b32 v144, 0xffff0000, v142
    v_add_f32 v143, v140, v143
    v_add_f32 v144, v141, v144
    v_cvt_pk_bf16_f32 v142, v143, v144
    v_lshlrev_b32 v143, 16, v142
    v_and_b32 v144, 0xffff0000, v142
    v_add_f32 v140, v140, v160
    v_add_f32 v141, v141, v160
    v_cvt_pk_bf16_f32 v145, v140, v141
    v_lshlrev_b32 v140, 16, v145
    v_and_b32 v141, 0xffff0000, v145
    v_mul_f32 v140, v140, v35
    v_mul_f32 v141, v141, v35
    v_cvt_pk_bf16_f32 v145, v140, v141
    v_lshlrev_b32 v140, 16, v145
    v_and_b32 v141, 0xffff0000, v145
    v_add_f32 v140, v140, v130
    v_add_f32 v141, v141, v131
    v_cvt_pk_bf16_f32 v145, v140, v141
    v_lshlrev_b32 v140, 16, v145
    v_and_b32 v141, 0xffff0000, v145
    v_add_f32 v140, v140, v143
    v_add_f32 v141, v141, v144
    v_cvt_pk_bf16_f32 v153, v140, v141
    v_lshlrev_b32 v140, 16, v32
    v_and_b32 v141, 0xffff0000, v32
    v_cvt_pk_bf16_f32 v142, v214, v215
    v_lshlrev_b32 v143, 16, v142
    v_and_b32 v144, 0xffff0000, v142
    v_add_f32 v143, v140, v143
    v_add_f32 v144, v141, v144
    v_cvt_pk_bf16_f32 v142, v143, v144
    v_lshlrev_b32 v143, 16, v142
    v_and_b32 v144, 0xffff0000, v142
    v_add_f32 v140, v140, v160
    v_add_f32 v141, v141, v160
    v_cvt_pk_bf16_f32 v145, v140, v141
    v_lshlrev_b32 v140, 16, v145
    v_and_b32 v141, 0xffff0000, v145
    v_mul_f32 v140, v140, v35
    v_mul_f32 v141, v141, v35
    v_cvt_pk_bf16_f32 v145, v140, v141
    v_lshlrev_b32 v140, 16, v145
    v_and_b32 v141, 0xffff0000, v145
    v_add_f32 v140, v140, v132
    v_add_f32 v141, v141, v133
    v_cvt_pk_bf16_f32 v145, v140, v141
    v_lshlrev_b32 v140, 16, v145
    v_and_b32 v141, 0xffff0000, v145
    v_add_f32 v140, v140, v143
    v_add_f32 v141, v141, v144
    v_cvt_pk_bf16_f32 v154, v140, v141
    v_lshlrev_b32 v140, 16, v33
    v_and_b32 v141, 0xffff0000, v33
    v_cvt_pk_bf16_f32 v142, v216, v217
    v_lshlrev_b32 v143, 16, v142
    v_and_b32 v144, 0xffff0000, v142
    v_add_f32 v143, v140, v143
    v_add_f32 v144, v141, v144
    v_cvt_pk_bf16_f32 v142, v143, v144
    v_lshlrev_b32 v143, 16, v142
    v_and_b32 v144, 0xffff0000, v142
    v_add_f32 v140, v140, v160
    v_add_f32 v141, v141, v160
    v_cvt_pk_bf16_f32 v145, v140, v141
    v_lshlrev_b32 v140, 16, v145
    v_and_b32 v141, 0xffff0000, v145
    v_mul_f32 v140, v140, v35
    v_mul_f32 v141, v141, v35
    v_cvt_pk_bf16_f32 v145, v140, v141
    v_lshlrev_b32 v140, 16, v145
    v_and_b32 v141, 0xffff0000, v145
    v_add_f32 v140, v140, v134
    v_add_f32 v141, v141, v135
    v_cvt_pk_bf16_f32 v145, v140, v141
    v_lshlrev_b32 v140, 16, v145
    v_and_b32 v141, 0xffff0000, v145
    v_add_f32 v140, v140, v143
    v_add_f32 v141, v141, v144
    v_cvt_pk_bf16_f32 v155, v140, v141
    buffer_store_dwordx4 v[148:151], v7, s[16:19], 0 offen
    buffer_store_dwordx4 v[152:155], v7, s[16:19], 0 offen offset:16
    s_branch K2_END
K2_AUX:
    v_lshrrev_b32 v10, 2, v0
    s_movk_i32 s38, 3072
    v_mul_lo_u32 v11, v10, s38
    v_and_b32 v12, 3, v0
    v_lshlrev_b32 v12, 4, v12
    s_lshl_b32 s39, s2, 6
    v_add3_u32 v2, v11, v12, s39
    s_mov_b32 s40, 0
    buffer_load_dwordx4 v[16:19], v2, s[20:23], s40 offen
    buffer_load_dwordx4 v[36:39], v2, s[24:27], s40 offen
    s_mov_b32 s40, 393216
    buffer_load_dwordx4 v[20:23], v2, s[20:23], s40 offen
    buffer_load_dwordx4 v[40:43], v2, s[24:27], s40 offen
    s_mov_b32 s40, 786432
    buffer_load_dwordx4 v[24:27], v2, s[20:23], s40 offen
    buffer_load_dwordx4 v[44:47], v2, s[24:27], s40 offen
    s_mov_b32 s40, 1179648
    buffer_load_dwordx4 v[28:31], v2, s[20:23], s40 offen
    buffer_load_dwordx4 v[48:51], v2, s[24:27], s40 offen
    s_mov_b32 s40, 1572864
    buffer_load_dwordx4 v[32:35], v2, s[20:23], s40 offen
    buffer_load_dwordx4 v[52:55], v2, s[24:27], s40 offen
    v_mul_u32_u24 v11, 205, v0
    v_lshrrev_b32 v11, 14, v11
    v_mul_u32_u24 v12, 80, v11
    v_sub_u32 v12, v0, v12
    v_lshlrev_b32 v13, 3, v11
    s_lshl_b32 s39, s2, 5
    v_add_u32 v13, s39, v13
    s_movk_i32 s38, 1280
    v_mul_lo_u32 v13, v13, s38
    v_lshlrev_b32 v14, 4, v12
    v_add_u32 v3, v13, v14
    v_mov_b32 v4, v11
    v_mov_b32 v5, v12
    s_cmp_ge_u32 s32, 5
    s_cbranch_scc1 K2A_NODL
    s_mov_b32 s40, 0
    buffer_load_dwordx4 v[56:59], v3, s[28:31], s40 offen
    s_mov_b32 s40, 1280
    buffer_load_dwordx4 v[60:63], v3, s[28:31], s40 offen
    s_mov_b32 s40, 2560
    buffer_load_dwordx4 v[64:67], v3, s[28:31], s40 offen
    s_mov_b32 s40, 3840
    buffer_load_dwordx4 v[68:71], v3, s[28:31], s40 offen
    s_mov_b32 s40, 5120
    buffer_load_dwordx4 v[72:75], v3, s[28:31], s40 offen
    s_mov_b32 s40, 6400
    buffer_load_dwordx4 v[76:79], v3, s[28:31], s40 offen
    s_mov_b32 s40, 7680
    buffer_load_dwordx4 v[80:83], v3, s[28:31], s40 offen
    s_mov_b32 s40, 8960
    buffer_load_dwordx4 v[84:87], v3, s[28:31], s40 offen
K2A_NODL:
    s_waitcnt lgkmcnt(0)
    s_mov_b32 s36, s80
    s_and_b32 s81, s80, 0x7ff
    s_sub_u32 s35, 2047, s81
    s_cmp_ge_u32 s32, 2
    s_cbranch_scc1 K2A_NOX
    s_mul_i32 s38, s35, 1280
    v_lshlrev_b32 v10, 4, v0
    s_lshl_b32 s39, s35, 3
    s_add_u32 s39, s39, 131072
    v_mov_b32 v11, 0
    buffer_load_dwordx4 v[96:99], v10, s[4:7], s38 offen
    buffer_load_dwordx2 v[100:101], v11, s[8:11], s39 offen
    s_waitcnt vmcnt(0)
    v_sub_f32 v102, 0, v100
    v_lshlrev_b32 v104, 16, v96
    v_and_b32 v105, 0xffff0000, v96
    v_lshlrev_b32 v106, 16, v97
    v_and_b32 v107, 0xffff0000, v97
    v_lshlrev_b32 v108, 16, v98
    v_and_b32 v109, 0xffff0000, v98
    v_lshlrev_b32 v110, 16, v99
    v_and_b32 v111, 0xffff0000, v99
    v_add_f32 v104, v104, v102
    v_add_f32 v105, v105, v102
    v_add_f32 v106, v106, v102
    v_add_f32 v107, v107, v102
    v_add_f32 v108, v108, v102
    v_add_f32 v109, v109, v102
    v_add_f32 v110, v110, v102
    v_add_f32 v111, v111, v102
    v_cvt_pk_bf16_f32 v96, v104, v105
    v_cvt_pk_bf16_f32 v97, v106, v107
    v_cvt_pk_bf16_f32 v98, v108, v109
    v_cvt_pk_bf16_f32 v99, v110, v111
    v_lshlrev_b32 v104, 16, v96
    v_and_b32 v105, 0xffff0000, v96
    v_lshlrev_b32 v106, 16, v97
    v_and_b32 v107, 0xffff0000, v97
    v_lshlrev_b32 v108, 16, v98
    v_and_b32 v109, 0xffff0000, v98
    v_lshlrev_b32 v110, 16, v99
    v_and_b32 v111, 0xffff0000, v99
    v_mul_f32 v104, v104, v101
    v_mul_f32 v105, v105, v101
    v_mul_f32 v106, v106, v101
    v_mul_f32 v107, v107, v101
    v_mul_f32 v108, v108, v101
    v_mul_f32 v109, v109, v101
    v_mul_f32 v110, v110, v101
    v_mul_f32 v111, v111, v101
    v_cvt_pk_bf16_f32 v96, v104, v105
    v_cvt_pk_bf16_f32 v97, v106, v107
    v_cvt_pk_bf16_f32 v98, v108, v109
    v_cvt_pk_bf16_f32 v99, v110, v111
    v_lshlrev_b32 v104, 16, v96
    v_and_b32 v105, 0xffff0000, v96
    v_lshlrev_b32 v106, 16, v97
    v_and_b32 v107, 0xffff0000, v97
    v_lshlrev_b32 v108, 16, v98
    v_and_b32 v109, 0xffff0000, v98
    v_lshlrev_b32 v110, 16, v99
    v_and_b32 v111, 0xffff0000, v99
    v_lshlrev_b32 v10, 5, v0
    v_cmp_gt_u32 vcc, 80, v0
    s_and_saveexec_b64 s[64:65], vcc
    ds_write_b128 v10, v[104:107] offset:0
    ds_write_b128 v10, v[108:111] offset:16
    s_mov_b64 exec, s[64:65]
K2A_NOX:
    s_waitcnt vmcnt(0) lgkmcnt(0)
    s_barrier
    v_lshrrev_b32 v10, 2, v0
    v_lshlrev_b32 v10, 2, v10
    ds_read_b32 v96, v10 offset:0
    ds_read_b32 v97, v10 offset:512
    ds_read_b32 v98, v10 offset:1024
    ds_read_b32 v99, v10 offset:1536
    ds_read_b32 v100, v10 offset:2048
    v_mov_b32 v104, 0
    v_mov_b32 v105, 0
    v_mov_b32 v106, 0
    v_mov_b32 v107, 0
    v_mov_b32 v108, 0
    v_mov_b32 v109, 0
    v_mov_b32 v110, 0
    v_mov_b32 v111, 0
    v_mov_b32 v112, 0
    v_mov_b32 v113, 0
    v_mov_b32 v114, 0
    v_mov_b32 v115, 0
    v_mov_b32 v116, 0
    v_mov_b32 v117, 0
    v_mov_b32 v118, 0
    v_mov_b32 v119, 0
    s_waitcnt lgkmcnt(0)
    v_lshlrev_b32 v120, 16, v16
    v_and_b32 v121, 0xffff0000, v16
    v_fmac_f32 v104, v120, v96
    v_fmac_f32 v105, v121, v96
    v_lshlrev_b32 v120, 16, v17
    v_and_b32 v121, 0xffff0000, v17
    v_fmac_f32 v106, v120, v96
    v_fmac_f32 v107, v121, v96
    v_lshlrev_b32 v120, 16, v18
    v_and_b32 v121, 0xffff0000, v18
    v_fmac_f32 v108, v120, v96
    v_fmac_f32 v109, v121, v96
    v_lshlrev_b32 v120, 16, v19
    v_and_b32 v121, 0xffff0000, v19
    v_fmac_f32 v110, v120, v96
    v_fmac_f32 v111, v121, v96
    v_lshlrev_b32 v120, 16, v36
    v_and_b32 v121, 0xffff0000, v36
    v_fmac_f32 v112, v120, v96
    v_fmac_f32 v113, v121, v96
    v_lshlrev_b32 v120, 16, v37
    v_and_b32 v121, 0xffff0000, v37
    v_fmac_f32 v114, v120, v96
    v_fmac_f32 v115, v121, v96
    v_lshlrev_b32 v120, 16, v38
    v_and_b32 v121, 0xffff0000, v38
    v_fmac_f32 v116, v120, v96
    v_fmac_f32 v117, v121, v96
    v_lshlrev_b32 v120, 16, v39
    v_and_b32 v121, 0xffff0000, v39
    v_fmac_f32 v118, v120, v96
    v_fmac_f32 v119, v121, v96
    v_lshlrev_b32 v120, 16, v20
    v_and_b32 v121, 0xffff0000, v20
    v_fmac_f32 v104, v120, v97
    v_fmac_f32 v105, v121, v97
    v_lshlrev_b32 v120, 16, v21
    v_and_b32 v121, 0xffff0000, v21
    v_fmac_f32 v106, v120, v97
    v_fmac_f32 v107, v121, v97
    v_lshlrev_b32 v120, 16, v22
    v_and_b32 v121, 0xffff0000, v22
    v_fmac_f32 v108, v120, v97
    v_fmac_f32 v109, v121, v97
    v_lshlrev_b32 v120, 16, v23
    v_and_b32 v121, 0xffff0000, v23
    v_fmac_f32 v110, v120, v97
    v_fmac_f32 v111, v121, v97
    v_lshlrev_b32 v120, 16, v40
    v_and_b32 v121, 0xffff0000, v40
    v_fmac_f32 v112, v120, v97
    v_fmac_f32 v113, v121, v97
    v_lshlrev_b32 v120, 16, v41
    v_and_b32 v121, 0xffff0000, v41
    v_fmac_f32 v114, v120, v97
    v_fmac_f32 v115, v121, v97
    v_lshlrev_b32 v120, 16, v42
    v_and_b32 v121, 0xffff0000, v42
    v_fmac_f32 v116, v120, v97
    v_fmac_f32 v117, v121, v97
    v_lshlrev_b32 v120, 16, v43
    v_and_b32 v121, 0xffff0000, v43
    v_fmac_f32 v118, v120, v97
    v_fmac_f32 v119, v121, v97
    v_lshlrev_b32 v120, 16, v24
    v_and_b32 v121, 0xffff0000, v24
    v_fmac_f32 v104, v120, v98
    v_fmac_f32 v105, v121, v98
    v_lshlrev_b32 v120, 16, v25
    v_and_b32 v121, 0xffff0000, v25
    v_fmac_f32 v106, v120, v98
    v_fmac_f32 v107, v121, v98
    v_lshlrev_b32 v120, 16, v26
    v_and_b32 v121, 0xffff0000, v26
    v_fmac_f32 v108, v120, v98
    v_fmac_f32 v109, v121, v98
    v_lshlrev_b32 v120, 16, v27
    v_and_b32 v121, 0xffff0000, v27
    v_fmac_f32 v110, v120, v98
    v_fmac_f32 v111, v121, v98
    v_lshlrev_b32 v120, 16, v44
    v_and_b32 v121, 0xffff0000, v44
    v_fmac_f32 v112, v120, v98
    v_fmac_f32 v113, v121, v98
    v_lshlrev_b32 v120, 16, v45
    v_and_b32 v121, 0xffff0000, v45
    v_fmac_f32 v114, v120, v98
    v_fmac_f32 v115, v121, v98
    v_lshlrev_b32 v120, 16, v46
    v_and_b32 v121, 0xffff0000, v46
    v_fmac_f32 v116, v120, v98
    v_fmac_f32 v117, v121, v98
    v_lshlrev_b32 v120, 16, v47
    v_and_b32 v121, 0xffff0000, v47
    v_fmac_f32 v118, v120, v98
    v_fmac_f32 v119, v121, v98
    v_lshlrev_b32 v120, 16, v28
    v_and_b32 v121, 0xffff0000, v28
    v_fmac_f32 v104, v120, v99
    v_fmac_f32 v105, v121, v99
    v_lshlrev_b32 v120, 16, v29
    v_and_b32 v121, 0xffff0000, v29
    v_fmac_f32 v106, v120, v99
    v_fmac_f32 v107, v121, v99
    v_lshlrev_b32 v120, 16, v30
    v_and_b32 v121, 0xffff0000, v30
    v_fmac_f32 v108, v120, v99
    v_fmac_f32 v109, v121, v99
    v_lshlrev_b32 v120, 16, v31
    v_and_b32 v121, 0xffff0000, v31
    v_fmac_f32 v110, v120, v99
    v_fmac_f32 v111, v121, v99
    v_lshlrev_b32 v120, 16, v48
    v_and_b32 v121, 0xffff0000, v48
    v_fmac_f32 v112, v120, v99
    v_fmac_f32 v113, v121, v99
    v_lshlrev_b32 v120, 16, v49
    v_and_b32 v121, 0xffff0000, v49
    v_fmac_f32 v114, v120, v99
    v_fmac_f32 v115, v121, v99
    v_lshlrev_b32 v120, 16, v50
    v_and_b32 v121, 0xffff0000, v50
    v_fmac_f32 v116, v120, v99
    v_fmac_f32 v117, v121, v99
    v_lshlrev_b32 v120, 16, v51
    v_and_b32 v121, 0xffff0000, v51
    v_fmac_f32 v118, v120, v99
    v_fmac_f32 v119, v121, v99
    v_lshlrev_b32 v120, 16, v32
    v_and_b32 v121, 0xffff0000, v32
    v_fmac_f32 v104, v120, v100
    v_fmac_f32 v105, v121, v100
    v_lshlrev_b32 v120, 16, v33
    v_and_b32 v121, 0xffff0000, v33
    v_fmac_f32 v106, v120, v100
    v_fmac_f32 v107, v121, v100
    v_lshlrev_b32 v120, 16, v34
    v_and_b32 v121, 0xffff0000, v34
    v_fmac_f32 v108, v120, v100
    v_fmac_f32 v109, v121, v100
    v_lshlrev_b32 v120, 16, v35
    v_and_b32 v121, 0xffff0000, v35
    v_fmac_f32 v110, v120, v100
    v_fmac_f32 v111, v121, v100
    v_lshlrev_b32 v120, 16, v52
    v_and_b32 v121, 0xffff0000, v52
    v_fmac_f32 v112, v120, v100
    v_fmac_f32 v113, v121, v100
    v_lshlrev_b32 v120, 16, v53
    v_and_b32 v121, 0xffff0000, v53
    v_fmac_f32 v114, v120, v100
    v_fmac_f32 v115, v121, v100
    v_lshlrev_b32 v120, 16, v54
    v_and_b32 v121, 0xffff0000, v54
    v_fmac_f32 v116, v120, v100
    v_fmac_f32 v117, v121, v100
    v_lshlrev_b32 v120, 16, v55
    v_and_b32 v121, 0xffff0000, v55
    v_fmac_f32 v118, v120, v100
    v_fmac_f32 v119, v121, v100
    s_nop 1
    v_add_f32_dpp v104, v104, v104 row_ror:4 row_mask:0xf bank_mask:0xf
    s_nop 1
    v_add_f32_dpp v105, v105, v105 row_ror:4 row_mask:0xf bank_mask:0xf
    s_nop 1
    v_add_f32_dpp v106, v106, v106 row_ror:4 row_mask:0xf bank_mask:0xf
    s_nop 1
    v_add_f32_dpp v107, v107, v107 row_ror:4 row_mask:0xf bank_mask:0xf
    s_nop 1
    v_add_f32_dpp v108, v108, v108 row_ror:4 row_mask:0xf bank_mask:0xf
    s_nop 1
    v_add_f32_dpp v109, v109, v109 row_ror:4 row_mask:0xf bank_mask:0xf
    s_nop 1
    v_add_f32_dpp v110, v110, v110 row_ror:4 row_mask:0xf bank_mask:0xf
    s_nop 1
    v_add_f32_dpp v111, v111, v111 row_ror:4 row_mask:0xf bank_mask:0xf
    s_nop 1
    v_add_f32_dpp v112, v112, v112 row_ror:4 row_mask:0xf bank_mask:0xf
    s_nop 1
    v_add_f32_dpp v113, v113, v113 row_ror:4 row_mask:0xf bank_mask:0xf
    s_nop 1
    v_add_f32_dpp v114, v114, v114 row_ror:4 row_mask:0xf bank_mask:0xf
    s_nop 1
    v_add_f32_dpp v115, v115, v115 row_ror:4 row_mask:0xf bank_mask:0xf
    s_nop 1
    v_add_f32_dpp v116, v116, v116 row_ror:4 row_mask:0xf bank_mask:0xf
    s_nop 1
    v_add_f32_dpp v117, v117, v117 row_ror:4 row_mask:0xf bank_mask:0xf
    s_nop 1
    v_add_f32_dpp v118, v118, v118 row_ror:4 row_mask:0xf bank_mask:0xf
    s_nop 1
    v_add_f32_dpp v119, v119, v119 row_ror:4 row_mask:0xf bank_mask:0xf
    s_nop 1
    v_add_f32_dpp v104, v104, v104 row_ror:8 row_mask:0xf bank_mask:0xf
    s_nop 1
    v_add_f32_dpp v105, v105, v105 row_ror:8 row_mask:0xf bank_mask:0xf
    s_nop 1
    v_add_f32_dpp v106, v106, v106 row_ror:8 row_mask:0xf bank_mask:0xf
    s_nop 1
    v_add_f32_dpp v107, v107, v107 row_ror:8 row_mask:0xf bank_mask:0xf
    s_nop 1
    v_add_f32_dpp v108, v108, v108 row_ror:8 row_mask:0xf bank_mask:0xf
    s_nop 1
    v_add_f32_dpp v109, v109, v109 row_ror:8 row_mask:0xf bank_mask:0xf
    s_nop 1
    v_add_f32_dpp v110, v110, v110 row_ror:8 row_mask:0xf bank_mask:0xf
    s_nop 1
    v_add_f32_dpp v111, v111, v111 row_ror:8 row_mask:0xf bank_mask:0xf
    s_nop 1
    v_add_f32_dpp v112, v112, v112 row_ror:8 row_mask:0xf bank_mask:0xf
    s_nop 1
    v_add_f32_dpp v113, v113, v113 row_ror:8 row_mask:0xf bank_mask:0xf
    s_nop 1
    v_add_f32_dpp v114, v114, v114 row_ror:8 row_mask:0xf bank_mask:0xf
    s_nop 1
    v_add_f32_dpp v115, v115, v115 row_ror:8 row_mask:0xf bank_mask:0xf
    s_nop 1
    v_add_f32_dpp v116, v116, v116 row_ror:8 row_mask:0xf bank_mask:0xf
    s_nop 1
    v_add_f32_dpp v117, v117, v117 row_ror:8 row_mask:0xf bank_mask:0xf
    s_nop 1
    v_add_f32_dpp v118, v118, v118 row_ror:8 row_mask:0xf bank_mask:0xf
    s_nop 1
    v_add_f32_dpp v119, v119, v119 row_ror:8 row_mask:0xf bank_mask:0xf
    v_mov_b32 v124, v104
    v_mov_b32 v125, v105
    v_mov_b32 v126, v106
    v_mov_b32 v127, v107
    v_mov_b32 v128, v108
    v_mov_b32 v129, v109
    v_mov_b32 v130, v110
    v_mov_b32 v131, v111
    v_mov_b32 v132, v112
    v_mov_b32 v133, v113
    v_mov_b32 v134, v114
    v_mov_b32 v135, v115
    v_mov_b32 v136, v116
    v_mov_b32 v137, v117
    v_mov_b32 v138, v118
    v_mov_b32 v139, v119
    s_nop 1
    v_permlane16_swap_b32 v104, v124
    v_permlane16_swap_b32 v105, v125
    v_permlane16_swap_b32 v106, v126
    v_permlane16_swap_b32 v107, v127
    v_permlane16_swap_b32 v108, v128
    v_permlane16_swap_b32 v109, v129
    v_permlane16_swap_b32 v110, v130
    v_permlane16_swap_b32 v111, v131
    v_permlane16_swap_b32 v112, v132
    v_permlane16_swap_b32 v113, v133
    v_permlane16_swap_b32 v114, v134
    v_permlane16_swap_b32 v115, v135
    v_permlane16_swap_b32 v116, v136
    v_permlane16_swap_b32 v117, v137
    v_permlane16_swap_b32 v118, v138
    v_permlane16_swap_b32 v119, v139
    s_nop 1
    v_add_f32 v104, v104, v124
    v_add_f32 v105, v105, v125
    v_add_f32 v106, v106, v126
    v_add_f32 v107, v107, v127
    v_add_f32 v108, v108, v128
    v_add_f32 v109, v109, v129
    v_add_f32 v110, v110, v130
    v_add_f32 v111, v111, v131
    v_add_f32 v112, v112, v132
    v_add_f32 v113, v113, v133
    v_add_f32 v114, v114, v134
    v_add_f32 v115, v115, v135
    v_add_f32 v116, v116, v136
    v_add_f32 v117, v117, v137
    v_add_f32 v118, v118, v138
    v_add_f32 v119, v119, v139
    v_mov_b32 v124, v104
    v_mov_b32 v125, v105
    v_mov_b32 v126, v106
    v_mov_b32 v127, v107
    v_mov_b32 v128, v108
    v_mov_b32 v129, v109
    v_mov_b32 v130, v110
    v_mov_b32 v131, v111
    v_mov_b32 v132, v112
    v_mov_b32 v133, v113
    v_mov_b32 v134, v114
    v_mov_b32 v135, v115
    v_mov_b32 v136, v116
    v_mov_b32 v137, v117
    v_mov_b32 v138, v118
    v_mov_b32 v139, v119
    s_nop 1
    v_permlane32_swap_b32 v104, v124
    v_permlane32_swap_b32 v105, v125
    v_permlane32_swap_b32 v106, v126
    v_permlane32_swap_b32 v107, v127
    v_permlane32_swap_b32 v108, v128
    v_permlane32_swap_b32 v109, v129
    v_permlane32_swap_b32 v110, v130
    v_permlane32_swap_b32 v111, v131
    v_permlane32_swap_b32 v112, v132
    v_permlane32_swap_b32 v113, v133
    v_permlane32_swap_b32 v114, v134
    v_permlane32_swap_b32 v115, v135
    v_permlane32_swap_b32 v116, v136
    v_permlane32_swap_b32 v117, v137
    v_permlane32_swap_b32 v118, v138
    v_permlane32_swap_b32 v119, v139
    s_nop 1
    v_add_f32 v104, v104, v124
    v_add_f32 v105, v105, v125
    v_add_f32 v106, v106, v126
    v_add_f32 v107, v107, v127
    v_add_f32 v108, v108, v128
    v_add_f32 v109, v109, v129
    v_add_f32 v110, v110, v130
    v_add_f32 v111, v111, v131
    v_add_f32 v112, v112, v132
    v_add_f32 v113, v113, v133
    v_add_f32 v114, v114, v134
    v_add_f32 v115, v115, v135
    v_add_f32 v116, v116, v136
    v_add_f32 v117, v117, v137
    v_add_f32 v118, v118, v138
    v_add_f32 v119, v119, v139
    s_lshl_b32 s38, s32, 8
    v_lshlrev_b32 v10, 5, v1
    v_add_u32 v10, s38, v10
    s_mov_b64 exec, 0xf
    ds_write_b128 v10, v[104:107] offset:4096
    ds_write_b128 v10, v[108:111] offset:4112
    ds_write_b128 v10, v[112:115] offset:4224
    ds_write_b128 v10, v[116:119] offset:4240
    s_mov_b64 exec, -1
    s_waitcnt lgkmcnt(0)
    s_barrier
    s_cmp_lg_u32 s32, 0
    s_cbranch_scc1 K2A_NOH
    v_and_b32 v10, 31, v1
    v_lshlrev_b32 v10, 2, v10
    ds_read_b32 v96, v10 offset:4096
    ds_read_b32 v104, v10 offset:4224
    ds_read_b32 v97, v10 offset:4352
    ds_read_b32 v105, v10 offset:4480
    ds_read_b32 v98, v10 offset:4608
    ds_read_b32 v106, v10 offset:4736
    ds_read_b32 v99, v10 offset:4864
    ds_read_b32 v107, v10 offset:4992
    ds_read_b32 v100, v10 offset:5120
    ds_read_b32 v108, v10 offset:5248
    ds_read_b32 v101, v10 offset:5376
    ds_read_b32 v109, v10 offset:5504
    ds_read_b32 v102, v10 offset:5632
    ds_read_b32 v110, v10 offset:5760
    ds_read_b32 v103, v10 offset:5888
    ds_read_b32 v111, v10 offset:6016
    s_waitcnt lgkmcnt(0)
    v_add_f32 v96, v96, v97
    v_add_f32 v104, v104, v105
    v_add_f32 v96, v96, v98
    v_add_f32 v104, v104, v106
    v_add_f32 v96, v96, v99
    v_add_f32 v104, v104, v107
    v_add_f32 v96, v96, v100
    v_add_f32 v104, v104, v108
    v_add_f32 v96, v96, v101
    v_add_f32 v104, v104, v109
    v_add_f32 v96, v96, v102
    v_add_f32 v104, v104, v110
    v_add_f32 v96, v96, v103
    v_add_f32 v104, v104, v111
    v_cvt_pk_bf16_f32 v97, v96, v104
    v_lshlrev_b32 v96, 16, v97
    v_and_b32 v104, 0xffff0000, v97
    v_mul_f32 v98, 0xbfb8aa3b, v96
    v_exp_f32 v98, v98
    s_nop 0
    v_add_f32 v98, 1.0, v98
    v_rcp_f32 v98, v98
    s_nop 0
    v_mul_f32 v98, v96, v98
    v_cvt_pk_bf16_f32 v98, v98, v98
    v_and_b32 v98, 0xffff0000, v98
    v_mul_f32 v98, v98, v104
    v_cvt_pk_bf16_f32 v98, v98, v98
    v_and_b32 v98, 0xffff0000, v98
    s_mov_b32 exec_hi, 0
    ds_write_b32 v10, v98 offset:8192
    s_mov_b64 exec, -1
K2A_NOH:
    s_waitcnt lgkmcnt(0)
    s_barrier
    s_cmp_ge_u32 s32, 5
    s_cbranch_scc1 K2A_NOD
    v_lshlrev_b32 v10, 5, v4
    ds_read_b128 v[96:99], v10 offset:8192
    ds_read_b128 v[100:103], v10 offset:8208
    v_mov_b32 v104, 0
    v_mov_b32 v105, 0
    v_mov_b32 v106, 0
    v_mov_b32 v107, 0
    v_mov_b32 v108, 0
    v_mov_b32 v109, 0
    v_mov_b32 v110, 0
    v_mov_b32 v111, 0
    s_waitcnt lgkmcnt(0)
    v_lshlrev_b32 v120, 16, v56
    v_and_b32 v121, 0xffff0000, v56
    v_fmac_f32 v104, v120, v96
    v_fmac_f32 v105, v121, v96
    v_lshlrev_b32 v120, 16, v57
    v_and_b32 v121, 0xffff0000, v57
    v_fmac_f32 v106, v120, v96
    v_fmac_f32 v107, v121, v96
    v_lshlrev_b32 v120, 16, v58
    v_and_b32 v121, 0xffff0000, v58
    v_fmac_f32 v108, v120, v96
    v_fmac_f32 v109, v121, v96
    v_lshlrev_b32 v120, 16, v59
    v_and_b32 v121, 0xffff0000, v59
    v_fmac_f32 v110, v120, v96
    v_fmac_f32 v111, v121, v96
    v_lshlrev_b32 v120, 16, v60
    v_and_b32 v121, 0xffff0000, v60
    v_fmac_f32 v104, v120, v97
    v_fmac_f32 v105, v121, v97
    v_lshlrev_b32 v120, 16, v61
    v_and_b32 v121, 0xffff0000, v61
    v_fmac_f32 v106, v120, v97
    v_fmac_f32 v107, v121, v97
    v_lshlrev_b32 v120, 16, v62
    v_and_b32 v121, 0xffff0000, v62
    v_fmac_f32 v108, v120, v97
    v_fmac_f32 v109, v121, v97
    v_lshlrev_b32 v120, 16, v63
    v_and_b32 v121, 0xffff0000, v63
    v_fmac_f32 v110, v120, v97
    v_fmac_f32 v111, v121, v97
    v_lshlrev_b32 v120, 16, v64
    v_and_b32 v121, 0xffff0000, v64
    v_fmac_f32 v104, v120, v98
    v_fmac_f32 v105, v121, v98
    v_lshlrev_b32 v120, 16, v65
    v_and_b32 v121, 0xffff0000, v65
    v_fmac_f32 v106, v120, v98
    v_fmac_f32 v107, v121, v98
    v_lshlrev_b32 v120, 16, v66
    v_and_b32 v121, 0xffff0000, v66
    v_fmac_f32 v108, v120, v98
    v_fmac_f32 v109, v121, v98
    v_lshlrev_b32 v120, 16, v67
    v_and_b32 v121, 0xffff0000, v67
    v_fmac_f32 v110, v120, v98
    v_fmac_f32 v111, v121, v98
    v_lshlrev_b32 v120, 16, v68
    v_and_b32 v121, 0xffff0000, v68
    v_fmac_f32 v104, v120, v99
    v_fmac_f32 v105, v121, v99
    v_lshlrev_b32 v120, 16, v69
    v_and_b32 v121, 0xffff0000, v69
    v_fmac_f32 v106, v120, v99
    v_fmac_f32 v107, v121, v99
    v_lshlrev_b32 v120, 16, v70
    v_and_b32 v121, 0xffff0000, v70
    v_fmac_f32 v108, v120, v99
    v_fmac_f32 v109, v121, v99
    v_lshlrev_b32 v120, 16, v71
    v_and_b32 v121, 0xffff0000, v71
    v_fmac_f32 v110, v120, v99
    v_fmac_f32 v111, v121, v99
    v_lshlrev_b32 v120, 16, v72
    v_and_b32 v121, 0xffff0000, v72
    v_fmac_f32 v104, v120, v100
    v_fmac_f32 v105, v121, v100
    v_lshlrev_b32 v120, 16, v73
    v_and_b32 v121, 0xffff0000, v73
    v_fmac_f32 v106, v120, v100
    v_fmac_f32 v107, v121, v100
    v_lshlrev_b32 v120, 16, v74
    v_and_b32 v121, 0xffff0000, v74
    v_fmac_f32 v108, v120, v100
    v_fmac_f32 v109, v121, v100
    v_lshlrev_b32 v120, 16, v75
    v_and_b32 v121, 0xffff0000, v75
    v_fmac_f32 v110, v120, v100
    v_fmac_f32 v111, v121, v100
    v_lshlrev_b32 v120, 16, v76
    v_and_b32 v121, 0xffff0000, v76
    v_fmac_f32 v104, v120, v101
    v_fmac_f32 v105, v121, v101
    v_lshlrev_b32 v120, 16, v77
    v_and_b32 v121, 0xffff0000, v77
    v_fmac_f32 v106, v120, v101
    v_fmac_f32 v107, v121, v101
    v_lshlrev_b32 v120, 16, v78
    v_and_b32 v121, 0xffff0000, v78
    v_fmac_f32 v108, v120, v101
    v_fmac_f32 v109, v121, v101
    v_lshlrev_b32 v120, 16, v79
    v_and_b32 v121, 0xffff0000, v79
    v_fmac_f32 v110, v120, v101
    v_fmac_f32 v111, v121, v101
    v_lshlrev_b32 v120, 16, v80
    v_and_b32 v121, 0xffff0000, v80
    v_fmac_f32 v104, v120, v102
    v_fmac_f32 v105, v121, v102
    v_lshlrev_b32 v120, 16, v81
    v_and_b32 v121, 0xffff0000, v81
    v_fmac_f32 v106, v120, v102
    v_fmac_f32 v107, v121, v102
    v_lshlrev_b32 v120, 16, v82
    v_and_b32 v121, 0xffff0000, v82
    v_fmac_f32 v108, v120, v102
    v_fmac_f32 v109, v121, v102
    v_lshlrev_b32 v120, 16, v83
    v_and_b32 v121, 0xffff0000, v83
    v_fmac_f32 v110, v120, v102
    v_fmac_f32 v111, v121, v102
    v_lshlrev_b32 v120, 16, v84
    v_and_b32 v121, 0xffff0000, v84
    v_fmac_f32 v104, v120, v103
    v_fmac_f32 v105, v121, v103
    v_lshlrev_b32 v120, 16, v85
    v_and_b32 v121, 0xffff0000, v85
    v_fmac_f32 v106, v120, v103
    v_fmac_f32 v107, v121, v103
    v_lshlrev_b32 v120, 16, v86
    v_and_b32 v121, 0xffff0000, v86
    v_fmac_f32 v108, v120, v103
    v_fmac_f32 v109, v121, v103
    v_lshlrev_b32 v120, 16, v87
    v_and_b32 v121, 0xffff0000, v87
    v_fmac_f32 v110, v120, v103
    v_fmac_f32 v111, v121, v103
    v_mul_u32_u24 v10, 2560, v4
    v_lshlrev_b32 v11, 5, v5
    v_add_u32 v10, v10, v11
    ds_write_b128 v10, v[104:107] offset:12288
    ds_write_b128 v10, v[108:111] offset:12304
K2A_NOD:
    s_waitcnt lgkmcnt(0)
    s_barrier
    s_cmp_ge_u32 s32, 3
    s_cbranch_scc1 K2A_NOS
    v_lshlrev_b32 v10, 4, v0
    ds_read_b128 v[96:99], v10 offset:12288
    ds_read_b128 v[100:103], v10 offset:14848
    ds_read_b128 v[104:107], v10 offset:17408
    ds_read_b128 v[108:111], v10 offset:19968
    s_waitcnt lgkmcnt(0)
    v_add_f32 v96, v96, v100
    v_add_f32 v104, v104, v108
    v_add_f32 v96, v96, v104
    v_add_f32 v97, v97, v101
    v_add_f32 v105, v105, v109
    v_add_f32 v97, v97, v105
    v_add_f32 v98, v98, v102
    v_add_f32 v106, v106, v110
    v_add_f32 v98, v98, v106
    v_add_f32 v99, v99, v103
    v_add_f32 v107, v107, v111
    v_add_f32 v99, v99, v107
    s_mul_i32 s38, s2, 2560
    s_add_u32 s38, s38, 196608
    v_cmp_gt_u32 vcc, 160, v0
    s_and_saveexec_b64 s[64:65], vcc
    buffer_store_dwordx4 v[96:99], v10, s[8:11], s38 offen sc0 sc1
    s_mov_b64 exec, s[64:65]
    s_waitcnt vmcnt(0)
K2A_NOS:
    s_barrier
    s_cmp_lg_u32 s32, 0
    s_cbranch_scc1 K2_END
    v_mov_b32 v10, 0
    v_mov_b32 v11, 1
    s_mov_b64 exec, 1
    buffer_atomic_add v11, v10, s[12:15], 0 offen
    s_mov_b64 exec, -1
    s_branch K2_END
K2_END:
    s_endpgm
.section .rodata,"a"
.p2align 6
.amdhsa_kernel k0_kernel
  .amdhsa_next_free_vgpr 64
  .amdhsa_next_free_sgpr 102
  .amdhsa_accum_offset 64
  .amdhsa_group_segment_fixed_size 0
  .amdhsa_kernarg_size 96
  .amdhsa_user_sgpr_count 2
  .amdhsa_user_sgpr_kernarg_segment_ptr 1
  .amdhsa_system_sgpr_workgroup_id_x 1
.end_amdhsa_kernel
.p2align 6
.amdhsa_kernel k1_kernel
  .amdhsa_next_free_vgpr 416
  .amdhsa_next_free_sgpr 102
  .amdhsa_accum_offset 256
  .amdhsa_group_segment_fixed_size 0
  .amdhsa_kernarg_size 96
  .amdhsa_user_sgpr_count 2
  .amdhsa_user_sgpr_kernarg_segment_ptr 1
  .amdhsa_system_sgpr_workgroup_id_x 1
.end_amdhsa_kernel
.p2align 6
.amdhsa_kernel k2_kernel
  .amdhsa_next_free_vgpr 256
  .amdhsa_next_free_sgpr 102
  .amdhsa_accum_offset 256
  .amdhsa_group_segment_fixed_size 0
  .amdhsa_kernarg_size 96
  .amdhsa_user_sgpr_count 2
  .amdhsa_user_sgpr_kernarg_segment_ptr 1
  .amdhsa_system_sgpr_workgroup_id_x 1
.end_amdhsa_kernel
```
